```python
import torch

def _softmax(x, axis=-1):
    return torch.softmax(x, dim=axis)
def _gelu(x):
    return torch.nn.functional.gelu(x, approximate="tanh")
def _silu(x):
    return torch.nn.functional.silu(x)
def _sigmoid(x):
    return torch.sigmoid(x)
def _layernorm(x, axis=-1, eps=1e-5):
    m = x.mean(dim=axis, keepdim=True)
    v = x.var(dim=axis, keepdim=True, unbiased=False)
    return (x - m) / torch.sqrt(v + eps)
def _scatter_add(tgt, idx, src, axis=0):
    return tgt.clone().index_add_(axis, idx, src)
def _segment_sum(src, seg, n):
    out = torch.zeros((n,) + src.shape[1:], dtype=src.dtype)
    return out.index_add_(0, seg, src)
def _pad(x, pw):
    flat = tuple(v for pair in reversed(pw) for v in pair)
    return torch.nn.functional.pad(x, flat)

kernel_name = 'standalone__weight_only_int_omniquant__prompt'

def setup_inputs():

    _w = (lambda a: (lambda t: t.to(torch.bfloat16) if t.is_floating_point() else t)(torch.as_tensor(a)))
    B, S, D, F = 1, 2048, 576, 4608
    bits = 8
    G = 64 if 64 > 0 else D
    D = (D // G) * G
    ng = D // G
    qmax = (1 << bits) - 1
    qw = torch.randint(0, qmax + 1, (D, F)).to(torch.int32)
    scales = (torch.abs((lambda *s: torch.randn(*s, dtype=torch.bfloat16) * 0.05)(ng, F)) * 0.05 + 0.01).to(float)
    zeros = torch.randint(0, qmax + 1, (ng, F)).to(float)
    act_scale = (torch.abs((lambda *s: torch.randn(*s, dtype=torch.bfloat16) * 0.05)(D)) * 0.5 + 0.5).to(float)
    return {
        "x": _w((lambda *s: torch.randn(*s, dtype=torch.bfloat16) * 0.05)(B, S, D)),
        "qw": _w(qw),
        "scales": _w(scales),
        "zeros": _w(zeros),
        "act_scale": _w(act_scale),
    }

def reference(x, qw, scales, zeros, act_scale):
    B, S, D = x.shape
    ng, F = scales.shape
    G = D // ng
    s = (lambda x, n, axis: torch.repeat_interleave(x, n, dim=axis))(scales, G, axis=0)
    z = (lambda x, n, axis: torch.repeat_interleave(x, n, dim=axis))(zeros, G, axis=0)
    w = ((lambda x, dt: x.to(dt))(qw, x.dtype) - z) * s
    xs = x * (lambda x, dt: x.to(dt))(act_scale, x.dtype)
    return torch.einsum("bsd,df->bsf", xs, w)
```

```asm
; @launch grid=(252,1,1) block=(512,1,1) lds=163840
.amdgcn_target "amdgcn-amd-amdhsa--gfx950"
.text
.globl standalone__weight_only_int_omniquant__prompt_kernel
.p2align 8
.type standalone__weight_only_int_omniquant__prompt_kernel,@function
standalone__weight_only_int_omniquant__prompt_kernel:
v_lshrrev_b32 v1, 6, v0
s_load_dwordx2 s[8:9], s[0:1], 0
v_readfirstlane_b32 s3, v1
s_cmp_ge_u32 s2, 252
s_cbranch_scc1 L_end
v_and_b32 v0, 63, v0
s_lshr_b32 s7, s2, 3
s_cmp_lt_u32 s3, 4
s_cselect_b32 s21, 24, 8
s_cmp_eq_u32 s3, 3
s_cselect_b32 s21, 32, s21
s_cselect_b32 s22, 32, 16
s_load_dwordx2 s[12:13], s[0:1], s21
s_load_dwordx2 s[16:17], s[0:1], s22
s_load_dwordx2 s[28:29], s[0:1], 40
s_mul_i32 s25, s7, 37
s_lshr_b32 s25, s25, 8
s_mul_i32 s6, s25, 7
s_sub_u32 s6, s7, s6
s_and_b32 s4, s2, 4
s_cmp_lt_u32 s7, 28
s_cselect_b32 s5, 7, 3
s_cselect_b32 s4, 0, s4
s_and_b32 s5, s2, s5
s_add_u32 s6, s6, s4
s_lshl3_add_u32 s5, s25, s5
s_lshl_b32 s21, s6, 2
s_lshr_b32 s20, 107225224, s21
s_and_b32 s20, s20, 15
s_mul_i32 s21, s25, 3
s_add_u32 s20, s20, s21
s_mul_i32 s21, s20, 7282
s_lshr_b32 s21, s21, 16
s_mul_i32 s21, s21, 9
s_sub_u32 s20, s20, s21
v_and_b32 v2, 15, v0
v_lshrrev_b32 v3, 4, v0
s_mov_b32 s57, 0
s_cmp_lt_u32 s3, 4
s_cbranch_scc1 L_cons
s_sub_u32 s24, s3, 4
s_lshr_b32 s27, s24, 1
s_and_b32 s26, s24, 1
s_mov_b32 s34, s25
s_lshl_b32 s21, s5, 1
s_add_u32 s21, s21, s27
s_lshl_b32 s21, s21, 8
s_mul_i32 s22, s26, 589824
s_add_u32 s21, s21, s22
s_mul_i32 s22, s20, 1179648
s_add_u32 s21, s21, s22
v_mul_u32_u24 v4, 147456, v3
v_lshl_add_u32 v4, v2, 4, v4
v_add_u32 v4, s21, v4
s_mov_b32 s21, s20
s_mov_b32 s14, 10616832
s_mov_b32 s15, 0x20000
s_mov_b32 s84, 18432
s_mov_b32 s85, 36864
s_mov_b32 s86, 55296
s_mov_b32 s87, 73728
s_mov_b32 s88, 92160
s_mov_b32 s89, 110592
s_mov_b32 s90, 129024
s_waitcnt lgkmcnt(0)
buffer_load_dwordx4 v[32:35], v4, s[12:15], 0 offen
buffer_load_dwordx4 v[36:39], v4, s[12:15], s84 offen
buffer_load_dwordx4 v[40:43], v4, s[12:15], s85 offen
buffer_load_dwordx4 v[44:47], v4, s[12:15], s86 offen
buffer_load_dwordx4 v[48:51], v4, s[12:15], s87 offen
buffer_load_dwordx4 v[52:55], v4, s[12:15], s88 offen
buffer_load_dwordx4 v[56:59], v4, s[12:15], s89 offen
buffer_load_dwordx4 v[60:63], v4, s[12:15], s90 offen
s_branch L_pmain
L_cons:
s_getpc_b64 s[36:37]
L_pc:
s_lshl_b32 s21, s7, 10
s_lshl_b32 s22, s3, 8
s_add_u32 s21, s21, s22
s_sub_u32 s36, s36, L_pc-standalone__weight_only_int_omniquant__prompt_kernel
s_subb_u32 s37, s37, 0
v_lshl_add_u32 v10, v0, 2, s21
v_min_u32 v10, L_end-standalone__weight_only_int_omniquant__prompt_kernel, v10
global_load_dword v13, v10, s[36:37]
s_mul_i32 s4, s6, 18
s_min_u32 s35, s6, 2
s_add_u32 s4, s4, s35
s_lshl_b32 s4, s4, 4
s_and_b32 s26, s3, 1
s_lshr_b32 s27, s3, 1
v_lshrrev_b32 v14, 3, v0
s_lshl_b32 s35, s26, 2
v_or_b32 v12, s35, v3
v_and_b32 v21, 7, v0
v_xor_b32 v12, v12, v21
s_lshl_b32 s35, s26, 3
s_add_u32 s35, s35, s4
v_add_u32 v15, s35, v14
v_mul_u32_u24 v6, 1152, v15
v_lshl_add_u32 v6, v12, 4, v6
s_mul_i32 s32, s27, 18432
s_lshl_b32 s33, s3, 10
s_lshl_b32 s31, s20, 7
s_mov_b32 s10, 2359296
s_mov_b32 s11, 0x20000
s_lshl_b32 s30, s27, 28
s_cmp_eq_u32 s3, 3
s_cselect_b32 s22, 0, s3
s_cselect_b64 vcc, -1, 0
s_lshl_b32 s22, s22, 2
v_cndmask_b32 v20, v3, v14, vcc
v_add_u32 v20, s22, v20
v_min_u32 v20, 8, v20
v_add_u32 v16, s20, v20
v_subrev_u32 v12, 9, v16
v_min_u32 v16, v16, v12
s_cmp_eq_u32 s3, 3
s_movk_i32 s22, 128
s_cselect_b32 s22, s22, 9216
v_cndmask_b32 v12, v2, v21, vcc
v_mul_u32_u24 v16, s22, v16
v_lshl_add_u32 v16, v12, 4, v16
s_add_u32 s22, s20, 8
s_sub_u32 s23, s22, 9
s_min_u32 s22, s22, s23
s_lshl_b32 s22, s22, 7
v_lshl_add_u32 v17, v21, 4, s22
v_cndmask_b32 v17, v16, v17, vcc
s_cmp_eq_u32 s3, 3
s_movk_i32 s18, 1152
s_cselect_b32 s18, s18, 82944
s_mov_b32 s19, 0x20000
s_mov_b32 s14, s18
s_mov_b32 s15, 0x20000
s_cselect_b32 s23, 0, s5
s_lshl_b32 s23, s23, 8
s_waitcnt lgkmcnt(0)
buffer_load_dwordx4 v[24:27], v16, s[16:19], s23 offen
buffer_load_dwordx4 v[28:31], v17, s[12:15], s23 offen
s_add_u32 m0, s33, 45056
s_add_u32 s35, s31, s32
buffer_load_dwordx4 v6, s[8:11], s35 offen   lds
s_add_u32 m0, s33, 49152
s_add_u32 s35, s35, 36864
buffer_load_dwordx4 v6, s[8:11], s35 offen   lds
s_add_u32 m0, s33, 53248
s_add_u32 s35, s35, 36864
buffer_load_dwordx4 v6, s[8:11], s35 offen   lds
s_add_u32 m0, s33, 57344
s_add_u32 s35, s35, 36864
buffer_load_dwordx4 v6, s[8:11], s35 offen   lds
s_add_u32 m0, s33, 61440
s_add_u32 s35, s35, 36864
buffer_load_dwordx4 v6, s[8:11], s35 offen   lds
s_add_u32 s31, s31, 128
s_cmp_eq_u32 s31, 1152
s_cselect_b32 s31, 0, s31
v_and_b32 v14, 1, v2
v_lshlrev_b32 v14, 3, v14
v_lshrrev_b32 v12, 1, v2
v_add_u32 v14, v14, v12
v_lshl_add_u32 v14, v3, 7, v14
s_lshl_b32 s21, s3, 5
v_add_u32 v14, s21, v14
v_lshlrev_b32 v4, 4, v14
s_lshl_b32 s21, s3, 2
v_add_u32 v14, s21, v3
v_xor_b32 v14, v14, v2
v_lshlrev_b32 v14, 3, v14
v_lshl_add_u32 v5, v2, 7, v14
v_lshlrev_b32 v22, 10, v20
v_lshl_add_u32 v22, v2, 5, v22
v_add_u32 v23, 512, v22
v_lshlrev_b32 v12, 5, v0
v_add_u32 v12, 9216, v12
v_cndmask_b32 v22, v22, v12, vcc
v_lshlrev_b32 v12, 5, v21
v_add_u32 v12, 11264, v12
v_cndmask_b32 v23, v23, v12, vcc
v_lshrrev_b32 v14, 1, v2
v_xor_b32 v14, v14, v3
v_lshlrev_b32 v14, 4, v14
v_lshl_add_u32 v14, v2, 7, v14
v_add_u32 v0, 45056, v14
v_xor_b32 v1, 64, v0
v_add_u32 v2, 103424, v14
v_xor_b32 v3, 64, v2
s_waitcnt vmcnt(7)
s_mov_b32 s57, 1
s_cmp_eq_u32 s3, 0
s_cbranch_scc1 L_pad0
s_cmp_eq_u32 s3, 1
s_cbranch_scc1 L_pad1
s_cmp_eq_u32 s3, 2
s_cbranch_scc1 L_pad2
s_branch L_pad3
L_wret:
s_mov_b32 s57, 0
s_mov_b32 s34, 0x4b800000
s_waitcnt vmcnt(5)
s_cmp_eq_u32 s3, 3
v_lshlrev_b32 v32, 16, v24
v_and_b32 v33, 0xffff0000, v24
v_lshlrev_b32 v40, 16, v28
v_and_b32 v41, 0xffff0000, v28
v_lshlrev_b32 v34, 16, v25
v_and_b32 v35, 0xffff0000, v25
v_lshlrev_b32 v42, 16, v29
v_and_b32 v43, 0xffff0000, v29
v_lshlrev_b32 v36, 16, v26
v_and_b32 v37, 0xffff0000, v26
v_lshlrev_b32 v44, 16, v30
v_and_b32 v45, 0xffff0000, v30
v_lshlrev_b32 v38, 16, v27
v_and_b32 v39, 0xffff0000, v27
v_lshlrev_b32 v46, 16, v31
v_and_b32 v47, 0xffff0000, v31
s_cbranch_scc1 L_nomul
v_mul_f32 v40, v40, v32
v_mul_f32 v32, s34, v32
v_mul_f32 v41, v41, v33
v_mul_f32 v33, s34, v33
v_mul_f32 v42, v42, v34
v_mul_f32 v34, s34, v34
v_mul_f32 v43, v43, v35
v_mul_f32 v35, s34, v35
v_mul_f32 v44, v44, v36
v_mul_f32 v36, s34, v36
v_mul_f32 v45, v45, v37
v_mul_f32 v37, s34, v37
v_mul_f32 v46, v46, v38
v_mul_f32 v38, s34, v38
v_mul_f32 v47, v47, v39
v_mul_f32 v39, s34, v39
L_nomul:
ds_write_b128 v22, v[32:35]
ds_write_b128 v22, v[36:39] offset:16
ds_write_b128 v23, v[40:43]
ds_write_b128 v23, v[44:47] offset:16
s_waitcnt lgkmcnt(0)
s_barrier
s_add_u32 m0, s33, 65536
s_add_u32 s35, s31, s32
buffer_load_dwordx4 v6, s[8:11], s35 offen   lds
s_add_u32 m0, s33, 69632
s_add_u32 s35, s35, 36864
buffer_load_dwordx4 v6, s[8:11], s35 offen   lds
s_add_u32 m0, s33, 73728
s_add_u32 s35, s35, 36864
buffer_load_dwordx4 v6, s[8:11], s35 offen   lds
s_add_u32 m0, s33, 77824
s_add_u32 s35, s35, 36864
buffer_load_dwordx4 v6, s[8:11], s35 offen   lds
s_add_u32 m0, s33, 81920
s_add_u32 s35, s35, 36864
buffer_load_dwordx4 v6, s[8:11], s35 offen   lds
s_add_u32 s31, s31, 128
s_cmp_eq_u32 s31, 1152
s_cselect_b32 s31, 0, s31
s_branch L_cmain
L_c18:
s_waitcnt lgkmcnt(6)
s_barrier
v_mfma_f32_16x16x32_bf16 v[32:35], v[200:203], v[12:15], v[32:35]
ds_read_b128 v[8:11], v2 offset:27648
v_mfma_f32_16x16x32_bf16 v[36:39], v[204:207], v[12:15], v[36:39]
s_waitcnt lgkmcnt(2)
v_mfma_f32_16x16x32_bf16 v[32:35], v[208:211], v[16:19], v[32:35]
ds_read_b128 v[12:15], v3 offset:27648
v_mfma_f32_16x16x32_bf16 v[36:39], v[212:215], v[16:19], v[36:39]
s_waitcnt lgkmcnt(2)
v_mfma_f32_16x16x32_bf16 v[32:35], v[216:219], v[20:23], v[32:35]
ds_read_b128 v[16:19], v2 offset:29696
v_mfma_f32_16x16x32_bf16 v[36:39], v[220:223], v[20:23], v[36:39]
s_waitcnt lgkmcnt(2)
v_mfma_f32_16x16x32_bf16 v[32:35], v[224:227], v[8:11], v[32:35]
ds_read_b128 v[20:23], v3 offset:29696
v_mfma_f32_16x16x32_bf16 v[36:39], v[228:231], v[8:11], v[36:39]
s_waitcnt lgkmcnt(2)
v_mfma_f32_16x16x32_bf16 v[32:35], v[232:235], v[12:15], v[32:35]
v_mfma_f32_16x16x32_bf16 v[36:39], v[236:239], v[12:15], v[36:39]
s_waitcnt lgkmcnt(1)
v_mfma_f32_16x16x32_bf16 v[32:35], v[240:243], v[16:19], v[32:35]
v_mfma_f32_16x16x32_bf16 v[36:39], v[244:247], v[16:19], v[36:39]
s_waitcnt lgkmcnt(0)
v_mfma_f32_16x16x32_bf16 v[32:35], v[248:251], v[20:23], v[32:35]
v_mfma_f32_16x16x32_bf16 v[36:39], v[252:255], v[20:23], v[36:39]
s_nop 7
v_cvt_pk_bf16_f32 v32, v32, v36
v_cvt_pk_bf16_f32 v33, v33, v37
v_cvt_pk_bf16_f32 v34, v34, v38
ds_write_b64 v5, v[32:33] offset:24576
v_cvt_pk_bf16_f32 v35, v35, v39
ds_write_b64 v5, v[34:35] offset:26624
s_waitcnt lgkmcnt(0)
s_barrier
s_endpgm
L_p18:
s_waitcnt lgkmcnt(0)
s_barrier
ds_read2st64_b64 v[96:99], v9 offset0:40 offset1:44
s_lshl_b32 s23, s66, 3
s_waitcnt lgkmcnt(0)
buffer_store_dwordx4 v[96:99], v10, s[28:31], s23 offen nt
s_waitcnt lgkmcnt(0)
s_barrier
ds_read2st64_b64 v[100:103], v9 offset0:48 offset1:52
s_lshl_b32 s23, s67, 3
s_waitcnt lgkmcnt(0)
buffer_store_dwordx4 v[100:103], v10, s[28:31], s23 offen nt
s_endpgm
.p2align 12
L_pmain:
s_mov_b32 s16, 4285530112
s_mov_b32 s17, 1179648
s_add_u32 s21, s21, 1
s_cmp_eq_u32 s21, 9
s_cselect_b32 s22, s16, s17
s_cselect_b32 s21, 0, s21
v_add_u32_e64 v4, s22, v4
v_lshrrev_b32 v11, 3, v2
v_lshlrev_b32 v11, 5, v11
v_and_b32 v12, 7, v2
v_add_u32 v11, v11, v12
v_lshl_add_u32 v11, v3, 7, v11
s_lshl_b32 s23, s27, 6
v_add_u32 v11, s23, v11
v_lshlrev_b32 v11, 4, v11
s_lshl_b32 s23, s26, 13
v_add_u32 v6, s23, v11
s_lshl_b32 s23, s27, 8
v_lshl_add_u32 v7, v2, 4, s23
s_lshl_b32 s23, s26, 7
s_add_u32 s23, s23, 9216
v_lshl_add_u32 v8, v3, 5, s23
s_mov_b32 s10, 2359296
s_mov_b32 s11, 0x20000
s_mul_i32 s4, s6, 18
s_min_u32 s35, s6, 2
s_add_u32 s4, s4, s35
s_lshl_b32 s4, s4, 4
v_lshrrev_b32 v11, 3, v0
s_lshl_b32 s23, s26, 2
v_or_b32 v12, s23, v3
v_and_b32 v13, 7, v0
v_xor_b32 v12, v12, v13
s_lshl_b32 s23, s26, 3
s_add_u32 s23, s23, s4
v_add_u32 v11, s23, v11
v_mul_u32_u24 v5, 1152, v11
v_lshl_add_u32 v5, v12, 4, v5
s_lshl_b32 s33, s24, 10
s_mov_b32 s30, 18874368
s_mov_b32 s31, 0x20000
s_lshl_b32 s23, s24, 2
v_add_u32 v11, s23, v3
v_xor_b32 v12, v11, v2
v_lshlrev_b32 v12, 3, v12
v_lshl_add_u32 v9, v11, 7, v12
v_add_u32 v11, s4, v11
v_mul_u32_u24 v11, 9216, v11
v_lshl_add_u32 v11, v2, 4, v11
s_lshl_b32 s23, s5, 8
v_add_u32 v10, s23, v11
s_add_u32 s35, s20, s27
s_sub_u32 s25, s35, 9
s_min_u32 s35, s35, s25
s_lshl_b32 s39, s35, 7
s_add_u32 s35, s35, 2
s_sub_u32 s25, s35, 9
s_min_u32 s35, s35, s25
s_lshl_b32 s40, s35, 7
s_add_u32 s35, s35, 2
s_sub_u32 s25, s35, 9
s_min_u32 s35, s35, s25
s_lshl_b32 s41, s35, 7
s_add_u32 s35, s35, 2
s_sub_u32 s25, s35, 9
s_min_u32 s35, s35, s25
s_lshl_b32 s42, s35, 7
s_add_u32 s35, s35, 2
s_sub_u32 s25, s35, 9
s_min_u32 s35, s35, s25
s_lshl_b32 s43, s35, 7
s_add_u32 s35, s35, 2
s_sub_u32 s25, s35, 9
s_min_u32 s35, s35, s25
s_lshl_b32 s44, s35, 7
s_add_u32 s35, s35, 2
s_sub_u32 s25, s35, 9
s_min_u32 s35, s35, s25
s_lshl_b32 s45, s35, 7
s_add_u32 s35, s35, 2
s_sub_u32 s25, s35, 9
s_min_u32 s35, s35, s25
s_lshl_b32 s46, s35, 7
s_add_u32 s35, s35, 2
s_sub_u32 s25, s35, 9
s_min_u32 s35, s35, s25
s_lshl_b32 s47, s35, 7
s_add_u32 s35, s35, 2
s_cmp_lt_u32 s6, 2
s_cselect_b32 s25, 9, 8
s_mul_i32 s18, s34, 2
s_mov_b32 s35, 7282
s_cselect_b32 s35, s35, 8192
s_mul_i32 s35, s35, s18
s_lshr_b32 s35, s35, 16
s_mul_i32 s35, s35, s25
s_sub_u32 s18, s18, s35
s_add_u32 s60, s18, 10
s_add_u32 s18, s18, 1
s_cmp_eq_u32 s18, s25
s_cselect_b32 s18, 0, s18
s_mul_i32 s60, s60, 18432
s_add_u32 s61, s18, 10
s_add_u32 s18, s18, 1
s_cmp_eq_u32 s18, s25
s_cselect_b32 s18, 0, s18
s_mul_i32 s61, s61, 18432
s_add_u32 s62, s18, 10
s_add_u32 s18, s18, 1
s_cmp_eq_u32 s18, s25
s_cselect_b32 s18, 0, s18
s_mul_i32 s62, s62, 18432
s_add_u32 s63, s18, 10
s_add_u32 s18, s18, 1
s_cmp_eq_u32 s18, s25
s_cselect_b32 s18, 0, s18
s_mul_i32 s63, s63, 18432
s_add_u32 s64, s18, 10
s_add_u32 s18, s18, 1
s_cmp_eq_u32 s18, s25
s_cselect_b32 s18, 0, s18
s_mul_i32 s64, s64, 18432
s_add_u32 s65, s18, 10
s_add_u32 s18, s18, 1
s_cmp_eq_u32 s18, s25
s_cselect_b32 s18, 0, s18
s_mul_i32 s65, s65, 18432
s_add_u32 s66, s18, 10
s_add_u32 s18, s18, 1
s_cmp_eq_u32 s18, s25
s_cselect_b32 s18, 0, s18
s_mul_i32 s66, s66, 18432
s_add_u32 s67, s18, 10
s_add_u32 s18, s18, 1
s_cmp_eq_u32 s18, s25
s_cselect_b32 s18, 0, s18
s_mul_i32 s67, s67, 18432
s_add_u32 s68, s18, 10
s_add_u32 s18, s18, 1
s_cmp_eq_u32 s18, s25
s_cselect_b32 s18, 0, s18
s_mul_i32 s68, s68, 18432
s_cmp_lt_u32 s6, 2
s_cselect_b32 s68, s68, 0x10000000
s_barrier
ds_read_b128 v[96:99], v7 offset:0
ds_read_b128 v[100:103], v7 offset:512
ds_read_b128 v[104:107], v8 offset:0
ds_read_b128 v[108:111], v8 offset:16
ds_read_b128 v[112:115], v7 offset:1024
ds_read_b128 v[116:119], v7 offset:1536
ds_read_b128 v[120:123], v8 offset:256
ds_read_b128 v[124:127], v8 offset:272
ds_read_b128 v[128:131], v7 offset:2048
ds_read_b128 v[132:135], v7 offset:2560
ds_read_b128 v[136:139], v8 offset:512
ds_read_b128 v[140:143], v8 offset:528
ds_read_b128 v[144:147], v7 offset:3072
ds_read_b128 v[148:151], v7 offset:3584
ds_read_b128 v[152:155], v8 offset:768
ds_read_b128 v[156:159], v8 offset:784
ds_read_b128 v[160:163], v7 offset:4096
ds_read_b128 v[164:167], v7 offset:4608
ds_read_b128 v[168:171], v8 offset:1024
ds_read_b128 v[172:175], v8 offset:1040
ds_read_b128 v[176:179], v7 offset:5120
ds_read_b128 v[180:183], v7 offset:5632
ds_read_b128 v[184:187], v8 offset:1280
ds_read_b128 v[188:191], v8 offset:1296
ds_read_b128 v[192:195], v7 offset:6144
ds_read_b128 v[196:199], v7 offset:6656
ds_read_b128 v[200:203], v8 offset:1536
ds_read_b128 v[204:207], v8 offset:1552
ds_read_b128 v[208:211], v7 offset:7168
ds_read_b128 v[212:215], v7 offset:7680
ds_read_b128 v[216:219], v8 offset:1792
ds_read_b128 v[220:223], v8 offset:1808
ds_read_b128 v[224:227], v7 offset:8192
ds_read_b128 v[228:231], v7 offset:8704
ds_read_b128 v[232:235], v8 offset:2048
ds_read_b128 v[236:239], v8 offset:2064
s_waitcnt lgkmcnt(0)
s_waitcnt vmcnt(6)
v_fma_mix_f32 v32, v32, v96, -v100 op_sel_hi:[1,0,0]
buffer_load_dwordx4 v[64:67], v4, s[12:15], 0 offen
v_fma_mix_f32 v36, v36, v96, -v100 op_sel_hi:[1,0,0]
v_fma_mix_f32 v33, v33, v97, -v101 op_sel_hi:[1,0,0]
v_fma_mix_f32 v37, v37, v97, -v101 op_sel_hi:[1,0,0]
v_fma_mix_f32 v34, v34, v98, -v102 op_sel_hi:[1,0,0]
v_fma_mix_f32 v38, v38, v98, -v102 op_sel_hi:[1,0,0]
buffer_load_dwordx4 v[68:71], v4, s[12:15], s84 offen
v_fma_mix_f32 v35, v35, v99, -v103 op_sel_hi:[1,0,0]
v_fma_mix_f32 v39, v39, v99, -v103 op_sel_hi:[1,0,0]
v_mul_f32_e32 v32, v32, v104
v_mul_f32_e64 v36, v36, v105
v_mul_f32_e64 v33, v33, v104
buffer_load_dwordx4 v[72:75], v4, s[12:15], s85 offen
v_mul_f32_e64 v37, v37, v105
v_mul_f32_e64 v34, v34, v104
v_mul_f32_e64 v38, v38, v105
v_mul_f32_e64 v35, v35, v104
v_mul_f32_e64 v39, v39, v105
buffer_load_dwordx4 v[76:79], v4, s[12:15], s86 offen
v_cvt_pk_bf16_f32 v16, v32, v36
v_cvt_pk_bf16_f32 v20, v33, v37
v_cvt_pk_bf16_f32 v24, v34, v38
v_cvt_pk_bf16_f32 v28, v35, v39
s_waitcnt vmcnt(8)
v_fma_mix_f32 v40, v40, v96, -v100 op_sel_hi:[1,0,0]
buffer_load_dwordx4 v[80:83], v4, s[12:15], s87 offen
v_fma_mix_f32 v44, v44, v96, -v100 op_sel_hi:[1,0,0]
v_fma_mix_f32 v41, v41, v97, -v101 op_sel_hi:[1,0,0]
v_fma_mix_f32 v45, v45, v97, -v101 op_sel_hi:[1,0,0]
v_fma_mix_f32 v42, v42, v98, -v102 op_sel_hi:[1,0,0]
v_fma_mix_f32 v46, v46, v98, -v102 op_sel_hi:[1,0,0]
buffer_load_dwordx4 v[84:87], v4, s[12:15], s88 offen
v_fma_mix_f32 v43, v43, v99, -v103 op_sel_hi:[1,0,0]
v_fma_mix_f32 v47, v47, v99, -v103 op_sel_hi:[1,0,0]
v_mul_f32_e32 v40, v40, v106
v_mul_f32_e64 v44, v44, v107
v_mul_f32_e64 v41, v41, v106
buffer_load_dwordx4 v[88:91], v4, s[12:15], s89 offen
v_mul_f32_e64 v45, v45, v107
v_mul_f32_e64 v42, v42, v106
v_mul_f32_e64 v46, v46, v107
v_mul_f32_e64 v43, v43, v106
v_mul_f32_e64 v47, v47, v107
buffer_load_dwordx4 v[92:95], v4, s[12:15], s90 offen
s_add_u32 s21, s21, 1
s_cmp_eq_u32 s21, 9
s_cselect_b32 s22, s16, s17
s_cselect_b32 s21, 0, s21
v_add_u32_e64 v4, s22, v4
v_cvt_pk_bf16_f32 v17, v40, v44
v_cvt_pk_bf16_f32 v21, v41, v45
v_cvt_pk_bf16_f32 v25, v42, v46
v_cvt_pk_bf16_f32 v29, v43, v47
s_waitcnt vmcnt(10)
v_fma_mix_f32 v48, v48, v96, -v100 op_sel_hi:[1,0,0]
v_fma_mix_f32 v52, v52, v96, -v100 op_sel_hi:[1,0,0]
v_fma_mix_f32 v49, v49, v97, -v101 op_sel_hi:[1,0,0]
v_fma_mix_f32 v53, v53, v97, -v101 op_sel_hi:[1,0,0]
v_fma_mix_f32 v50, v50, v98, -v102 op_sel_hi:[1,0,0]
v_fma_mix_f32 v54, v54, v98, -v102 op_sel_hi:[1,0,0]
v_fma_mix_f32 v51, v51, v99, -v103 op_sel_hi:[1,0,0]
v_fma_mix_f32 v55, v55, v99, -v103 op_sel_hi:[1,0,0]
v_mul_f32_e32 v48, v48, v108
v_mul_f32_e64 v52, v52, v109
v_mul_f32_e64 v49, v49, v108
v_mul_f32_e64 v53, v53, v109
v_mul_f32_e64 v50, v50, v108
v_mul_f32_e64 v54, v54, v109
v_mul_f32_e64 v51, v51, v108
v_mul_f32_e64 v55, v55, v109
v_cvt_pk_bf16_f32 v18, v48, v52
v_cvt_pk_bf16_f32 v22, v49, v53
v_cvt_pk_bf16_f32 v26, v50, v54
v_cvt_pk_bf16_f32 v30, v51, v55
s_waitcnt vmcnt(8)
v_fma_mix_f32 v56, v56, v96, -v100 op_sel_hi:[1,0,0]
v_fma_mix_f32 v60, v60, v96, -v100 op_sel_hi:[1,0,0]
v_fma_mix_f32 v57, v57, v97, -v101 op_sel_hi:[1,0,0]
v_fma_mix_f32 v61, v61, v97, -v101 op_sel_hi:[1,0,0]
v_fma_mix_f32 v58, v58, v98, -v102 op_sel_hi:[1,0,0]
v_fma_mix_f32 v62, v62, v98, -v102 op_sel_hi:[1,0,0]
v_fma_mix_f32 v59, v59, v99, -v103 op_sel_hi:[1,0,0]
v_fma_mix_f32 v63, v63, v99, -v103 op_sel_hi:[1,0,0]
v_mul_f32_e32 v56, v56, v110
v_mul_f32_e64 v60, v60, v111
v_mul_f32_e64 v57, v57, v110
v_mul_f32_e64 v61, v61, v111
v_mul_f32_e64 v58, v58, v110
v_mul_f32_e64 v62, v62, v111
v_mul_f32_e64 v59, v59, v110
v_mul_f32_e64 v63, v63, v111
v_cvt_pk_bf16_f32 v19, v56, v60
ds_write_b128 v6, v[16:19] offset:28672
v_cvt_pk_bf16_f32 v23, v57, v61
ds_write_b128 v6, v[20:23] offset:28928
v_cvt_pk_bf16_f32 v27, v58, v62
ds_write_b128 v6, v[24:27] offset:28800
v_cvt_pk_bf16_f32 v31, v59, v63
ds_write_b128 v6, v[28:31] offset:29056
s_waitcnt lgkmcnt(0)
s_barrier
s_waitcnt vmcnt(6)
v_fma_mix_f32 v64, v64, v112, -v116 op_sel_hi:[1,0,0]
v_fma_mix_f32 v68, v68, v112, -v116 op_sel_hi:[1,0,0]
v_fma_mix_f32 v65, v65, v113, -v117 op_sel_hi:[1,0,0]
v_fma_mix_f32 v69, v69, v113, -v117 op_sel_hi:[1,0,0]
v_fma_mix_f32 v66, v66, v114, -v118 op_sel_hi:[1,0,0]
v_fma_mix_f32 v70, v70, v114, -v118 op_sel_hi:[1,0,0]
v_fma_mix_f32 v67, v67, v115, -v119 op_sel_hi:[1,0,0]
v_fma_mix_f32 v71, v71, v115, -v119 op_sel_hi:[1,0,0]
buffer_load_dwordx4 v[32:35], v4, s[12:15], 0 offen
v_mul_f32_e32 v64, v64, v120
v_mul_f32_e64 v68, v68, v121
v_mul_f32_e64 v65, v65, v120
v_mul_f32_e64 v69, v69, v121
v_mul_f32_e64 v66, v66, v120
buffer_load_dwordx4 v[36:39], v4, s[12:15], s84 offen
v_mul_f32_e64 v70, v70, v121
v_mul_f32_e64 v67, v67, v120
v_mul_f32_e64 v71, v71, v121
v_cvt_pk_bf16_f32 v16, v64, v68
v_cvt_pk_bf16_f32 v20, v65, v69
buffer_load_dwordx4 v[40:43], v4, s[12:15], s85 offen
v_cvt_pk_bf16_f32 v24, v66, v70
v_cvt_pk_bf16_f32 v28, v67, v71
s_waitcnt vmcnt(7)
v_fma_mix_f32 v72, v72, v112, -v116 op_sel_hi:[1,0,0]
v_fma_mix_f32 v76, v76, v112, -v116 op_sel_hi:[1,0,0]
v_fma_mix_f32 v73, v73, v113, -v117 op_sel_hi:[1,0,0]
buffer_load_dwordx4 v[44:47], v4, s[12:15], s86 offen
v_fma_mix_f32 v77, v77, v113, -v117 op_sel_hi:[1,0,0]
v_fma_mix_f32 v74, v74, v114, -v118 op_sel_hi:[1,0,0]
v_fma_mix_f32 v78, v78, v114, -v118 op_sel_hi:[1,0,0]
v_fma_mix_f32 v75, v75, v115, -v119 op_sel_hi:[1,0,0]
v_fma_mix_f32 v79, v79, v115, -v119 op_sel_hi:[1,0,0]
buffer_load_dwordx4 v[48:51], v4, s[12:15], s87 offen
v_mul_f32_e32 v72, v72, v122
v_mul_f32_e64 v76, v76, v123
v_mul_f32_e64 v73, v73, v122
v_mul_f32_e64 v77, v77, v123
v_mul_f32_e64 v74, v74, v122
buffer_load_dwordx4 v[52:55], v4, s[12:15], s88 offen
v_mul_f32_e64 v78, v78, v123
v_mul_f32_e64 v75, v75, v122
v_mul_f32_e64 v79, v79, v123
v_cvt_pk_bf16_f32 v17, v72, v76
v_cvt_pk_bf16_f32 v21, v73, v77
buffer_load_dwordx4 v[56:59], v4, s[12:15], s89 offen
v_cvt_pk_bf16_f32 v25, v74, v78
v_cvt_pk_bf16_f32 v29, v75, v79
s_waitcnt vmcnt(9)
v_fma_mix_f32 v80, v80, v112, -v116 op_sel_hi:[1,0,0]
v_fma_mix_f32 v84, v84, v112, -v116 op_sel_hi:[1,0,0]
v_fma_mix_f32 v81, v81, v113, -v117 op_sel_hi:[1,0,0]
buffer_load_dwordx4 v[60:63], v4, s[12:15], s90 offen
s_add_u32 s21, s21, 1
s_cmp_eq_u32 s21, 9
s_cselect_b32 s22, s16, s17
s_cselect_b32 s21, 0, s21
v_add_u32_e64 v4, s22, v4
v_fma_mix_f32 v85, v85, v113, -v117 op_sel_hi:[1,0,0]
v_fma_mix_f32 v82, v82, v114, -v118 op_sel_hi:[1,0,0]
v_fma_mix_f32 v86, v86, v114, -v118 op_sel_hi:[1,0,0]
v_fma_mix_f32 v83, v83, v115, -v119 op_sel_hi:[1,0,0]
v_fma_mix_f32 v87, v87, v115, -v119 op_sel_hi:[1,0,0]
v_mul_f32_e32 v80, v80, v124
v_mul_f32_e64 v84, v84, v125
buffer_load_dwordx4 v[64:67], v4, s[12:15], 0 offen
v_mul_f32_e64 v81, v81, v124
v_mul_f32_e64 v85, v85, v125
v_mul_f32_e64 v82, v82, v124
v_mul_f32_e64 v86, v86, v125
v_mul_f32_e64 v83, v83, v124
buffer_load_dwordx4 v[68:71], v4, s[12:15], s84 offen
v_mul_f32_e64 v87, v87, v125
v_cvt_pk_bf16_f32 v18, v80, v84
v_cvt_pk_bf16_f32 v22, v81, v85
v_cvt_pk_bf16_f32 v26, v82, v86
v_cvt_pk_bf16_f32 v30, v83, v87
s_waitcnt vmcnt(10)
v_fma_mix_f32 v88, v88, v112, -v116 op_sel_hi:[1,0,0]
buffer_load_dwordx4 v[72:75], v4, s[12:15], s85 offen
v_fma_mix_f32 v92, v92, v112, -v116 op_sel_hi:[1,0,0]
v_fma_mix_f32 v89, v89, v113, -v117 op_sel_hi:[1,0,0]
v_fma_mix_f32 v93, v93, v113, -v117 op_sel_hi:[1,0,0]
v_fma_mix_f32 v90, v90, v114, -v118 op_sel_hi:[1,0,0]
v_fma_mix_f32 v94, v94, v114, -v118 op_sel_hi:[1,0,0]
buffer_load_dwordx4 v[76:79], v4, s[12:15], s86 offen
v_fma_mix_f32 v91, v91, v115, -v119 op_sel_hi:[1,0,0]
v_fma_mix_f32 v95, v95, v115, -v119 op_sel_hi:[1,0,0]
v_mul_f32_e32 v88, v88, v126
v_mul_f32_e64 v92, v92, v127
v_mul_f32_e64 v89, v89, v126
v_mul_f32_e64 v93, v93, v127
buffer_load_dwordx4 v[80:83], v4, s[12:15], s87 offen
v_mul_f32_e64 v90, v90, v126
v_mul_f32_e64 v94, v94, v127
v_mul_f32_e64 v91, v91, v126
v_mul_f32_e64 v95, v95, v127
v_cvt_pk_bf16_f32 v19, v88, v92
buffer_load_dwordx4 v[84:87], v4, s[12:15], s88 offen
ds_write_b128 v6, v[16:19] offset:12288
v_cvt_pk_bf16_f32 v23, v89, v93
ds_write_b128 v6, v[20:23] offset:12544
v_cvt_pk_bf16_f32 v27, v90, v94
ds_write_b128 v6, v[24:27] offset:12416
v_cvt_pk_bf16_f32 v31, v91, v95
ds_write_b128 v6, v[28:31] offset:12672
s_waitcnt vmcnt(12)
v_fma_mix_f32 v32, v32, v128, -v132 op_sel_hi:[1,0,0]
v_fma_mix_f32 v36, v36, v128, -v132 op_sel_hi:[1,0,0]
v_fma_mix_f32 v33, v33, v129, -v133 op_sel_hi:[1,0,0]
buffer_load_dwordx4 v[88:91], v4, s[12:15], s89 offen
v_fma_mix_f32 v37, v37, v129, -v133 op_sel_hi:[1,0,0]
v_fma_mix_f32 v34, v34, v130, -v134 op_sel_hi:[1,0,0]
v_fma_mix_f32 v38, v38, v130, -v134 op_sel_hi:[1,0,0]
s_waitcnt lgkmcnt(0)
s_barrier
v_fma_mix_f32 v35, v35, v131, -v135 op_sel_hi:[1,0,0]
v_fma_mix_f32 v39, v39, v131, -v135 op_sel_hi:[1,0,0]
buffer_load_dwordx4 v[92:95], v4, s[12:15], s90 offen
s_add_u32 s21, s21, 1
s_cmp_eq_u32 s21, 9
s_cselect_b32 s22, s16, s17
s_cselect_b32 s21, 0, s21
v_add_u32_e64 v4, s22, v4
v_mul_f32_e32 v32, v32, v136
v_mul_f32_e64 v36, v36, v137
v_mul_f32_e64 v33, v33, v136
v_mul_f32_e64 v37, v37, v137
v_mul_f32_e64 v34, v34, v136
v_mul_f32_e64 v38, v38, v137
v_mul_f32_e64 v35, v35, v136
v_mul_f32_e64 v39, v39, v137
v_cvt_pk_bf16_f32 v16, v32, v36
v_cvt_pk_bf16_f32 v20, v33, v37
v_cvt_pk_bf16_f32 v24, v34, v38
v_cvt_pk_bf16_f32 v28, v35, v39
s_waitcnt vmcnt(12)
v_fma_mix_f32 v40, v40, v128, -v132 op_sel_hi:[1,0,0]
v_fma_mix_f32 v44, v44, v128, -v132 op_sel_hi:[1,0,0]
v_fma_mix_f32 v41, v41, v129, -v133 op_sel_hi:[1,0,0]
v_fma_mix_f32 v45, v45, v129, -v133 op_sel_hi:[1,0,0]
v_fma_mix_f32 v42, v42, v130, -v134 op_sel_hi:[1,0,0]
v_fma_mix_f32 v46, v46, v130, -v134 op_sel_hi:[1,0,0]
v_fma_mix_f32 v43, v43, v131, -v135 op_sel_hi:[1,0,0]
v_fma_mix_f32 v47, v47, v131, -v135 op_sel_hi:[1,0,0]
v_mul_f32_e32 v40, v40, v138
v_mul_f32_e64 v44, v44, v139
v_mul_f32_e64 v41, v41, v138
v_mul_f32_e64 v45, v45, v139
v_mul_f32_e64 v42, v42, v138
v_mul_f32_e64 v46, v46, v139
v_mul_f32_e64 v43, v43, v138
v_mul_f32_e64 v47, v47, v139
v_cvt_pk_bf16_f32 v17, v40, v44
v_cvt_pk_bf16_f32 v21, v41, v45
v_cvt_pk_bf16_f32 v25, v42, v46
v_cvt_pk_bf16_f32 v29, v43, v47
s_waitcnt vmcnt(10)
v_fma_mix_f32 v48, v48, v128, -v132 op_sel_hi:[1,0,0]
v_fma_mix_f32 v52, v52, v128, -v132 op_sel_hi:[1,0,0]
v_fma_mix_f32 v49, v49, v129, -v133 op_sel_hi:[1,0,0]
v_fma_mix_f32 v53, v53, v129, -v133 op_sel_hi:[1,0,0]
v_fma_mix_f32 v50, v50, v130, -v134 op_sel_hi:[1,0,0]
v_fma_mix_f32 v54, v54, v130, -v134 op_sel_hi:[1,0,0]
v_fma_mix_f32 v51, v51, v131, -v135 op_sel_hi:[1,0,0]
v_fma_mix_f32 v55, v55, v131, -v135 op_sel_hi:[1,0,0]
v_mul_f32_e32 v48, v48, v140
v_mul_f32_e64 v52, v52, v141
buffer_load_dwordx4 v[96:99], v4, s[12:15], 0 offen
v_mul_f32_e64 v49, v49, v140
v_mul_f32_e64 v53, v53, v141
v_mul_f32_e64 v50, v50, v140
v_mul_f32_e64 v54, v54, v141
v_mul_f32_e64 v51, v51, v140
buffer_load_dwordx4 v[100:103], v4, s[12:15], s84 offen
v_mul_f32_e64 v55, v55, v141
v_cvt_pk_bf16_f32 v18, v48, v52
v_cvt_pk_bf16_f32 v22, v49, v53
v_cvt_pk_bf16_f32 v26, v50, v54
v_cvt_pk_bf16_f32 v30, v51, v55
s_waitcnt vmcnt(10)
v_fma_mix_f32 v56, v56, v128, -v132 op_sel_hi:[1,0,0]
buffer_load_dwordx4 v[104:107], v4, s[12:15], s85 offen
v_fma_mix_f32 v60, v60, v128, -v132 op_sel_hi:[1,0,0]
v_fma_mix_f32 v57, v57, v129, -v133 op_sel_hi:[1,0,0]
v_fma_mix_f32 v61, v61, v129, -v133 op_sel_hi:[1,0,0]
v_fma_mix_f32 v58, v58, v130, -v134 op_sel_hi:[1,0,0]
v_fma_mix_f32 v62, v62, v130, -v134 op_sel_hi:[1,0,0]
buffer_load_dwordx4 v[108:111], v4, s[12:15], s86 offen
v_fma_mix_f32 v59, v59, v131, -v135 op_sel_hi:[1,0,0]
v_fma_mix_f32 v63, v63, v131, -v135 op_sel_hi:[1,0,0]
v_mul_f32_e32 v56, v56, v142
v_mul_f32_e64 v60, v60, v143
v_mul_f32_e64 v57, v57, v142
v_mul_f32_e64 v61, v61, v143
buffer_load_dwordx4 v[112:115], v4, s[12:15], s87 offen
v_mul_f32_e64 v58, v58, v142
v_mul_f32_e64 v62, v62, v143
v_mul_f32_e64 v59, v59, v142
s_waitcnt vmcnt(5)
v_mul_f32_e32 v63, v63, v143
v_cvt_pk_bf16_f32 v19, v56, v60
buffer_load_dwordx4 v[116:119], v4, s[12:15], s88 offen
ds_write_b128 v6, v[16:19] offset:28672
v_cvt_pk_bf16_f32 v23, v57, v61
ds_write_b128 v6, v[20:23] offset:28928
v_cvt_pk_bf16_f32 v27, v58, v62
ds_write_b128 v6, v[24:27] offset:28800
v_cvt_pk_bf16_f32 v31, v59, v63
ds_write_b128 v6, v[28:31] offset:29056
v_fma_mix_f32 v64, v64, v144, -v148 op_sel_hi:[1,0,0]
v_fma_mix_f32 v68, v68, v144, -v148 op_sel_hi:[1,0,0]
v_fma_mix_f32 v72, v72, v144, -v148 op_sel_hi:[1,0,0]
buffer_load_dwordx4 v[120:123], v4, s[12:15], s89 offen
v_fma_mix_f32 v76, v76, v144, -v148 op_sel_hi:[1,0,0]
v_fma_mix_f32 v80, v80, v144, -v148 op_sel_hi:[1,0,0]
v_fma_mix_f32 v84, v84, v144, -v148 op_sel_hi:[1,0,0]
s_waitcnt lgkmcnt(0)
s_barrier
v_fma_mix_f32 v88, v88, v144, -v148 op_sel_hi:[1,0,0]
v_fma_mix_f32 v92, v92, v144, -v148 op_sel_hi:[1,0,0]
buffer_load_dwordx4 v[124:127], v4, s[12:15], s90 offen
s_add_u32 s21, s21, 1
s_cmp_eq_u32 s21, 9
s_cselect_b32 s22, s16, s17
s_cselect_b32 s21, 0, s21
v_add_u32_e64 v4, s22, v4
v_mul_f32_e64 v64, v64, v152
v_mul_f32_e64 v68, v68, v153
v_mul_f32_e64 v72, v72, v154
v_mul_f32_e64 v76, v76, v155
v_mul_f32_e64 v80, v80, v156
v_mul_f32_e64 v84, v84, v157
v_mul_f32_e64 v88, v88, v158
v_mul_f32_e64 v92, v92, v159
v_cvt_pk_bf16_f32 v16, v64, v68
v_cvt_pk_bf16_f32 v17, v72, v76
v_cvt_pk_bf16_f32 v18, v80, v84
v_cvt_pk_bf16_f32 v19, v88, v92
ds_write_b128 v6, v[16:19] offset:12288
v_fma_mix_f32 v65, v65, v145, -v149 op_sel_hi:[1,0,0]
v_fma_mix_f32 v69, v69, v145, -v149 op_sel_hi:[1,0,0]
v_fma_mix_f32 v73, v73, v145, -v149 op_sel_hi:[1,0,0]
v_fma_mix_f32 v77, v77, v145, -v149 op_sel_hi:[1,0,0]
v_fma_mix_f32 v81, v81, v145, -v149 op_sel_hi:[1,0,0]
v_fma_mix_f32 v85, v85, v145, -v149 op_sel_hi:[1,0,0]
v_fma_mix_f32 v89, v89, v145, -v149 op_sel_hi:[1,0,0]
v_fma_mix_f32 v93, v93, v145, -v149 op_sel_hi:[1,0,0]
v_mul_f32_e64 v65, v65, v152
v_mul_f32_e64 v69, v69, v153
v_mul_f32_e64 v73, v73, v154
v_mul_f32_e64 v77, v77, v155
v_mul_f32_e64 v81, v81, v156
v_mul_f32_e64 v85, v85, v157
v_mul_f32_e64 v89, v89, v158
v_mul_f32_e64 v93, v93, v159
v_cvt_pk_bf16_f32 v20, v65, v69
v_cvt_pk_bf16_f32 v21, v73, v77
v_cvt_pk_bf16_f32 v22, v81, v85
v_cvt_pk_bf16_f32 v23, v89, v93
v_fma_mix_f32 v66, v66, v146, -v150 op_sel_hi:[1,0,0]
v_fma_mix_f32 v70, v70, v146, -v150 op_sel_hi:[1,0,0]
v_fma_mix_f32 v74, v74, v146, -v150 op_sel_hi:[1,0,0]
v_fma_mix_f32 v78, v78, v146, -v150 op_sel_hi:[1,0,0]
v_fma_mix_f32 v82, v82, v146, -v150 op_sel_hi:[1,0,0]
v_fma_mix_f32 v86, v86, v146, -v150 op_sel_hi:[1,0,0]
v_fma_mix_f32 v90, v90, v146, -v150 op_sel_hi:[1,0,0]
v_fma_mix_f32 v94, v94, v146, -v150 op_sel_hi:[1,0,0]
v_mul_f32_e64 v66, v66, v152
v_mul_f32_e64 v70, v70, v153
buffer_load_dwordx4 v[32:35], v4, s[12:15], 0 offen
v_mul_f32_e64 v74, v74, v154
v_mul_f32_e64 v78, v78, v155
v_mul_f32_e64 v82, v82, v156
v_mul_f32_e64 v86, v86, v157
v_mul_f32_e64 v90, v90, v158
buffer_load_dwordx4 v[36:39], v4, s[12:15], s84 offen
v_mul_f32_e64 v94, v94, v159
v_cvt_pk_bf16_f32 v24, v66, v70
v_cvt_pk_bf16_f32 v25, v74, v78
v_cvt_pk_bf16_f32 v26, v82, v86
v_cvt_pk_bf16_f32 v27, v90, v94
v_fma_mix_f32 v67, v67, v147, -v151 op_sel_hi:[1,0,0]
buffer_load_dwordx4 v[40:43], v4, s[12:15], s85 offen
v_fma_mix_f32 v71, v71, v147, -v151 op_sel_hi:[1,0,0]
v_fma_mix_f32 v75, v75, v147, -v151 op_sel_hi:[1,0,0]
v_fma_mix_f32 v79, v79, v147, -v151 op_sel_hi:[1,0,0]
v_fma_mix_f32 v83, v83, v147, -v151 op_sel_hi:[1,0,0]
v_fma_mix_f32 v87, v87, v147, -v151 op_sel_hi:[1,0,0]
buffer_load_dwordx4 v[44:47], v4, s[12:15], s86 offen
v_fma_mix_f32 v91, v91, v147, -v151 op_sel_hi:[1,0,0]
v_fma_mix_f32 v95, v95, v147, -v151 op_sel_hi:[1,0,0]
v_mul_f32_e64 v67, v67, v152
v_mul_f32_e64 v71, v71, v153
v_mul_f32_e64 v75, v75, v154
v_mul_f32_e64 v79, v79, v155
buffer_load_dwordx4 v[48:51], v4, s[12:15], s87 offen
v_mul_f32_e64 v83, v83, v156
v_mul_f32_e64 v87, v87, v157
v_mul_f32_e64 v91, v91, v158
s_waitcnt vmcnt(5)
v_mul_f32_e32 v95, v95, v159
v_cvt_pk_bf16_f32 v28, v67, v71
buffer_load_dwordx4 v[52:55], v4, s[12:15], s88 offen
v_cvt_pk_bf16_f32 v29, v75, v79
v_cvt_pk_bf16_f32 v30, v83, v87
v_cvt_pk_bf16_f32 v31, v91, v95
ds_write_b128 v6, v[20:23] offset:12544
ds_write_b128 v6, v[24:27] offset:12416
ds_write_b128 v6, v[28:31] offset:12672
L_pad0:
s_cmp_eq_u32 s57, 1
s_cbranch_scc1 L_wret
v_fma_mix_f32 v96, v96, v160, -v164 op_sel_hi:[1,0,0]
v_fma_mix_f32 v100, v100, v160, -v164 op_sel_hi:[1,0,0]
v_fma_mix_f32 v104, v104, v160, -v164 op_sel_hi:[1,0,0]
buffer_load_dwordx4 v[56:59], v4, s[12:15], s89 offen
v_fma_mix_f32 v108, v108, v160, -v164 op_sel_hi:[1,0,0]
v_fma_mix_f32 v112, v112, v160, -v164 op_sel_hi:[1,0,0]
v_fma_mix_f32 v116, v116, v160, -v164 op_sel_hi:[1,0,0]
s_waitcnt lgkmcnt(0)
s_barrier
v_fma_mix_f32 v120, v120, v160, -v164 op_sel_hi:[1,0,0]
v_fma_mix_f32 v124, v124, v160, -v164 op_sel_hi:[1,0,0]
buffer_load_dwordx4 v[60:63], v4, s[12:15], s90 offen
s_add_u32 s21, s21, 1
s_cmp_eq_u32 s21, 9
s_cselect_b32 s22, s16, s17
s_cselect_b32 s21, 0, s21
v_add_u32_e64 v4, s22, v4
v_mul_f32_e64 v96, v96, v168
v_mul_f32_e64 v100, v100, v169
v_mul_f32_e64 v104, v104, v170
v_mul_f32_e64 v108, v108, v171
v_mul_f32_e64 v112, v112, v172
v_mul_f32_e64 v116, v116, v173
v_mul_f32_e64 v120, v120, v174
v_mul_f32_e64 v124, v124, v175
v_cvt_pk_bf16_f32 v16, v96, v100
v_cvt_pk_bf16_f32 v17, v104, v108
v_cvt_pk_bf16_f32 v18, v112, v116
v_cvt_pk_bf16_f32 v19, v120, v124
ds_write_b128 v6, v[16:19] offset:28672
v_fma_mix_f32 v97, v97, v161, -v165 op_sel_hi:[1,0,0]
v_fma_mix_f32 v101, v101, v161, -v165 op_sel_hi:[1,0,0]
v_fma_mix_f32 v105, v105, v161, -v165 op_sel_hi:[1,0,0]
v_fma_mix_f32 v109, v109, v161, -v165 op_sel_hi:[1,0,0]
v_fma_mix_f32 v113, v113, v161, -v165 op_sel_hi:[1,0,0]
v_fma_mix_f32 v117, v117, v161, -v165 op_sel_hi:[1,0,0]
v_fma_mix_f32 v121, v121, v161, -v165 op_sel_hi:[1,0,0]
v_fma_mix_f32 v125, v125, v161, -v165 op_sel_hi:[1,0,0]
v_mul_f32_e64 v97, v97, v168
v_mul_f32_e64 v101, v101, v169
v_mul_f32_e64 v105, v105, v170
v_mul_f32_e64 v109, v109, v171
v_mul_f32_e64 v113, v113, v172
v_mul_f32_e64 v117, v117, v173
v_mul_f32_e64 v121, v121, v174
v_mul_f32_e64 v125, v125, v175
v_cvt_pk_bf16_f32 v20, v97, v101
v_cvt_pk_bf16_f32 v21, v105, v109
v_cvt_pk_bf16_f32 v22, v113, v117
v_cvt_pk_bf16_f32 v23, v121, v125
v_fma_mix_f32 v98, v98, v162, -v166 op_sel_hi:[1,0,0]
v_fma_mix_f32 v102, v102, v162, -v166 op_sel_hi:[1,0,0]
v_fma_mix_f32 v106, v106, v162, -v166 op_sel_hi:[1,0,0]
v_fma_mix_f32 v110, v110, v162, -v166 op_sel_hi:[1,0,0]
v_fma_mix_f32 v114, v114, v162, -v166 op_sel_hi:[1,0,0]
v_fma_mix_f32 v118, v118, v162, -v166 op_sel_hi:[1,0,0]
v_fma_mix_f32 v122, v122, v162, -v166 op_sel_hi:[1,0,0]
v_fma_mix_f32 v126, v126, v162, -v166 op_sel_hi:[1,0,0]
v_mul_f32_e64 v98, v98, v168
v_mul_f32_e64 v102, v102, v169
buffer_load_dwordx4 v[64:67], v4, s[12:15], 0 offen
v_mul_f32_e64 v106, v106, v170
v_mul_f32_e64 v110, v110, v171
v_mul_f32_e64 v114, v114, v172
v_mul_f32_e64 v118, v118, v173
v_mul_f32_e64 v122, v122, v174
buffer_load_dwordx4 v[68:71], v4, s[12:15], s84 offen
v_mul_f32_e64 v126, v126, v175
v_cvt_pk_bf16_f32 v24, v98, v102
v_cvt_pk_bf16_f32 v25, v106, v110
v_cvt_pk_bf16_f32 v26, v114, v118
v_cvt_pk_bf16_f32 v27, v122, v126
v_fma_mix_f32 v99, v99, v163, -v167 op_sel_hi:[1,0,0]
buffer_load_dwordx4 v[72:75], v4, s[12:15], s85 offen
v_fma_mix_f32 v103, v103, v163, -v167 op_sel_hi:[1,0,0]
v_fma_mix_f32 v107, v107, v163, -v167 op_sel_hi:[1,0,0]
v_fma_mix_f32 v111, v111, v163, -v167 op_sel_hi:[1,0,0]
v_fma_mix_f32 v115, v115, v163, -v167 op_sel_hi:[1,0,0]
v_fma_mix_f32 v119, v119, v163, -v167 op_sel_hi:[1,0,0]
buffer_load_dwordx4 v[76:79], v4, s[12:15], s86 offen
v_fma_mix_f32 v123, v123, v163, -v167 op_sel_hi:[1,0,0]
v_fma_mix_f32 v127, v127, v163, -v167 op_sel_hi:[1,0,0]
v_mul_f32_e64 v99, v99, v168
v_mul_f32_e64 v103, v103, v169
v_mul_f32_e64 v107, v107, v170
v_mul_f32_e64 v111, v111, v171
buffer_load_dwordx4 v[80:83], v4, s[12:15], s87 offen
v_mul_f32_e64 v115, v115, v172
v_mul_f32_e64 v119, v119, v173
v_mul_f32_e64 v123, v123, v174
s_waitcnt vmcnt(5)
v_mul_f32_e32 v127, v127, v175
v_cvt_pk_bf16_f32 v28, v99, v103
buffer_load_dwordx4 v[84:87], v4, s[12:15], s88 offen
v_cvt_pk_bf16_f32 v29, v107, v111
v_cvt_pk_bf16_f32 v30, v115, v119
v_cvt_pk_bf16_f32 v31, v123, v127
ds_write_b128 v6, v[20:23] offset:28928
ds_write_b128 v6, v[24:27] offset:28800
ds_write_b128 v6, v[28:31] offset:29056
v_fma_mix_f32 v32, v32, v176, -v180 op_sel_hi:[1,0,0]
v_fma_mix_f32 v36, v36, v176, -v180 op_sel_hi:[1,0,0]
v_fma_mix_f32 v40, v40, v176, -v180 op_sel_hi:[1,0,0]
buffer_load_dwordx4 v[88:91], v4, s[12:15], s89 offen
v_fma_mix_f32 v44, v44, v176, -v180 op_sel_hi:[1,0,0]
v_fma_mix_f32 v48, v48, v176, -v180 op_sel_hi:[1,0,0]
v_fma_mix_f32 v52, v52, v176, -v180 op_sel_hi:[1,0,0]
s_waitcnt lgkmcnt(0)
s_barrier
v_fma_mix_f32 v56, v56, v176, -v180 op_sel_hi:[1,0,0]
v_fma_mix_f32 v60, v60, v176, -v180 op_sel_hi:[1,0,0]
buffer_load_dwordx4 v[92:95], v4, s[12:15], s90 offen
s_add_u32 s21, s21, 1
s_cmp_eq_u32 s21, 9
s_cselect_b32 s22, s16, s17
s_cselect_b32 s21, 0, s21
v_add_u32_e64 v4, s22, v4
v_mul_f32_e64 v32, v32, v184
v_mul_f32_e64 v36, v36, v185
v_mul_f32_e64 v40, v40, v186
v_mul_f32_e64 v44, v44, v187
v_mul_f32_e64 v48, v48, v188
v_mul_f32_e64 v52, v52, v189
v_mul_f32_e64 v56, v56, v190
v_mul_f32_e64 v60, v60, v191
v_cvt_pk_bf16_f32 v16, v32, v36
v_cvt_pk_bf16_f32 v17, v40, v44
v_cvt_pk_bf16_f32 v18, v48, v52
v_cvt_pk_bf16_f32 v19, v56, v60
ds_write_b128 v6, v[16:19] offset:12288
v_fma_mix_f32 v33, v33, v177, -v181 op_sel_hi:[1,0,0]
v_fma_mix_f32 v37, v37, v177, -v181 op_sel_hi:[1,0,0]
v_fma_mix_f32 v41, v41, v177, -v181 op_sel_hi:[1,0,0]
v_fma_mix_f32 v45, v45, v177, -v181 op_sel_hi:[1,0,0]
v_fma_mix_f32 v49, v49, v177, -v181 op_sel_hi:[1,0,0]
v_fma_mix_f32 v53, v53, v177, -v181 op_sel_hi:[1,0,0]
v_fma_mix_f32 v57, v57, v177, -v181 op_sel_hi:[1,0,0]
v_fma_mix_f32 v61, v61, v177, -v181 op_sel_hi:[1,0,0]
v_mul_f32_e64 v33, v33, v184
v_mul_f32_e64 v37, v37, v185
v_mul_f32_e64 v41, v41, v186
v_mul_f32_e64 v45, v45, v187
v_mul_f32_e64 v49, v49, v188
v_mul_f32_e64 v53, v53, v189
v_mul_f32_e64 v57, v57, v190
v_mul_f32_e64 v61, v61, v191
v_cvt_pk_bf16_f32 v20, v33, v37
v_cvt_pk_bf16_f32 v21, v41, v45
v_cvt_pk_bf16_f32 v22, v49, v53
v_cvt_pk_bf16_f32 v23, v57, v61
v_fma_mix_f32 v34, v34, v178, -v182 op_sel_hi:[1,0,0]
v_fma_mix_f32 v38, v38, v178, -v182 op_sel_hi:[1,0,0]
v_fma_mix_f32 v42, v42, v178, -v182 op_sel_hi:[1,0,0]
v_fma_mix_f32 v46, v46, v178, -v182 op_sel_hi:[1,0,0]
v_fma_mix_f32 v50, v50, v178, -v182 op_sel_hi:[1,0,0]
v_fma_mix_f32 v54, v54, v178, -v182 op_sel_hi:[1,0,0]
v_fma_mix_f32 v58, v58, v178, -v182 op_sel_hi:[1,0,0]
v_fma_mix_f32 v62, v62, v178, -v182 op_sel_hi:[1,0,0]
v_mul_f32_e64 v34, v34, v184
v_mul_f32_e64 v38, v38, v185
buffer_load_dwordx4 v[96:99], v4, s[12:15], 0 offen
v_mul_f32_e64 v42, v42, v186
v_mul_f32_e64 v46, v46, v187
v_mul_f32_e64 v50, v50, v188
v_mul_f32_e64 v54, v54, v189
v_mul_f32_e64 v58, v58, v190
buffer_load_dwordx4 v[100:103], v4, s[12:15], s84 offen
v_mul_f32_e64 v62, v62, v191
v_cvt_pk_bf16_f32 v24, v34, v38
v_cvt_pk_bf16_f32 v25, v42, v46
v_cvt_pk_bf16_f32 v26, v50, v54
v_cvt_pk_bf16_f32 v27, v58, v62
v_fma_mix_f32 v35, v35, v179, -v183 op_sel_hi:[1,0,0]
buffer_load_dwordx4 v[104:107], v4, s[12:15], s85 offen
v_fma_mix_f32 v39, v39, v179, -v183 op_sel_hi:[1,0,0]
v_fma_mix_f32 v43, v43, v179, -v183 op_sel_hi:[1,0,0]
v_fma_mix_f32 v47, v47, v179, -v183 op_sel_hi:[1,0,0]
v_fma_mix_f32 v51, v51, v179, -v183 op_sel_hi:[1,0,0]
v_fma_mix_f32 v55, v55, v179, -v183 op_sel_hi:[1,0,0]
buffer_load_dwordx4 v[108:111], v4, s[12:15], s86 offen
v_fma_mix_f32 v59, v59, v179, -v183 op_sel_hi:[1,0,0]
v_fma_mix_f32 v63, v63, v179, -v183 op_sel_hi:[1,0,0]
v_mul_f32_e64 v35, v35, v184
v_mul_f32_e64 v39, v39, v185
v_mul_f32_e64 v43, v43, v186
v_mul_f32_e64 v47, v47, v187
buffer_load_dwordx4 v[112:115], v4, s[12:15], s87 offen
v_mul_f32_e64 v51, v51, v188
v_mul_f32_e64 v55, v55, v189
v_mul_f32_e64 v59, v59, v190
s_waitcnt vmcnt(5)
v_mul_f32_e32 v63, v63, v191
v_cvt_pk_bf16_f32 v28, v35, v39
buffer_load_dwordx4 v[116:119], v4, s[12:15], s88 offen
v_cvt_pk_bf16_f32 v29, v43, v47
v_cvt_pk_bf16_f32 v30, v51, v55
v_cvt_pk_bf16_f32 v31, v59, v63
ds_write_b128 v6, v[20:23] offset:12544
ds_write_b128 v6, v[24:27] offset:12416
ds_write_b128 v6, v[28:31] offset:12672
v_fma_mix_f32 v64, v64, v192, -v196 op_sel_hi:[1,0,0]
v_fma_mix_f32 v68, v68, v192, -v196 op_sel_hi:[1,0,0]
v_fma_mix_f32 v72, v72, v192, -v196 op_sel_hi:[1,0,0]
buffer_load_dwordx4 v[120:123], v4, s[12:15], s89 offen
v_fma_mix_f32 v76, v76, v192, -v196 op_sel_hi:[1,0,0]
v_fma_mix_f32 v80, v80, v192, -v196 op_sel_hi:[1,0,0]
v_fma_mix_f32 v84, v84, v192, -v196 op_sel_hi:[1,0,0]
s_waitcnt lgkmcnt(0)
s_barrier
v_fma_mix_f32 v88, v88, v192, -v196 op_sel_hi:[1,0,0]
v_fma_mix_f32 v92, v92, v192, -v196 op_sel_hi:[1,0,0]
buffer_load_dwordx4 v[124:127], v4, s[12:15], s90 offen
s_add_u32 s21, s21, 1
s_cmp_eq_u32 s21, 9
s_cselect_b32 s22, s16, s17
s_cselect_b32 s21, 0, s21
v_add_u32_e64 v4, s22, v4
v_mul_f32_e64 v64, v64, v200
v_mul_f32_e64 v68, v68, v201
v_mul_f32_e64 v72, v72, v202
v_mul_f32_e64 v76, v76, v203
v_mul_f32_e64 v80, v80, v204
v_mul_f32_e64 v84, v84, v205
v_mul_f32_e64 v88, v88, v206
v_mul_f32_e64 v92, v92, v207
v_cvt_pk_bf16_f32 v16, v64, v68
v_cvt_pk_bf16_f32 v17, v72, v76
v_cvt_pk_bf16_f32 v18, v80, v84
v_cvt_pk_bf16_f32 v19, v88, v92
ds_write_b128 v6, v[16:19] offset:28672
v_fma_mix_f32 v65, v65, v193, -v197 op_sel_hi:[1,0,0]
v_fma_mix_f32 v69, v69, v193, -v197 op_sel_hi:[1,0,0]
v_fma_mix_f32 v73, v73, v193, -v197 op_sel_hi:[1,0,0]
v_fma_mix_f32 v77, v77, v193, -v197 op_sel_hi:[1,0,0]
v_fma_mix_f32 v81, v81, v193, -v197 op_sel_hi:[1,0,0]
v_fma_mix_f32 v85, v85, v193, -v197 op_sel_hi:[1,0,0]
v_fma_mix_f32 v89, v89, v193, -v197 op_sel_hi:[1,0,0]
v_fma_mix_f32 v93, v93, v193, -v197 op_sel_hi:[1,0,0]
v_mul_f32_e64 v65, v65, v200
v_mul_f32_e64 v69, v69, v201
v_mul_f32_e64 v73, v73, v202
v_mul_f32_e64 v77, v77, v203
v_mul_f32_e64 v81, v81, v204
v_mul_f32_e64 v85, v85, v205
v_mul_f32_e64 v89, v89, v206
v_mul_f32_e64 v93, v93, v207
v_cvt_pk_bf16_f32 v20, v65, v69
v_cvt_pk_bf16_f32 v21, v73, v77
v_cvt_pk_bf16_f32 v22, v81, v85
v_cvt_pk_bf16_f32 v23, v89, v93
v_fma_mix_f32 v66, v66, v194, -v198 op_sel_hi:[1,0,0]
v_fma_mix_f32 v70, v70, v194, -v198 op_sel_hi:[1,0,0]
v_fma_mix_f32 v74, v74, v194, -v198 op_sel_hi:[1,0,0]
v_fma_mix_f32 v78, v78, v194, -v198 op_sel_hi:[1,0,0]
v_fma_mix_f32 v82, v82, v194, -v198 op_sel_hi:[1,0,0]
v_fma_mix_f32 v86, v86, v194, -v198 op_sel_hi:[1,0,0]
v_fma_mix_f32 v90, v90, v194, -v198 op_sel_hi:[1,0,0]
v_fma_mix_f32 v94, v94, v194, -v198 op_sel_hi:[1,0,0]
v_mul_f32_e64 v66, v66, v200
v_mul_f32_e64 v70, v70, v201
buffer_load_dwordx4 v[32:35], v4, s[12:15], 0 offen
v_mul_f32_e64 v74, v74, v202
v_mul_f32_e64 v78, v78, v203
v_mul_f32_e64 v82, v82, v204
v_mul_f32_e64 v86, v86, v205
v_mul_f32_e64 v90, v90, v206
buffer_load_dwordx4 v[36:39], v4, s[12:15], s84 offen
v_mul_f32_e64 v94, v94, v207
v_cvt_pk_bf16_f32 v24, v66, v70
v_cvt_pk_bf16_f32 v25, v74, v78
v_cvt_pk_bf16_f32 v26, v82, v86
v_cvt_pk_bf16_f32 v27, v90, v94
v_fma_mix_f32 v67, v67, v195, -v199 op_sel_hi:[1,0,0]
buffer_load_dwordx4 v[40:43], v4, s[12:15], s85 offen
v_fma_mix_f32 v71, v71, v195, -v199 op_sel_hi:[1,0,0]
v_fma_mix_f32 v75, v75, v195, -v199 op_sel_hi:[1,0,0]
v_fma_mix_f32 v79, v79, v195, -v199 op_sel_hi:[1,0,0]
v_fma_mix_f32 v83, v83, v195, -v199 op_sel_hi:[1,0,0]
v_fma_mix_f32 v87, v87, v195, -v199 op_sel_hi:[1,0,0]
buffer_load_dwordx4 v[44:47], v4, s[12:15], s86 offen
v_fma_mix_f32 v91, v91, v195, -v199 op_sel_hi:[1,0,0]
v_fma_mix_f32 v95, v95, v195, -v199 op_sel_hi:[1,0,0]
v_mul_f32_e64 v67, v67, v200
v_mul_f32_e64 v71, v71, v201
v_mul_f32_e64 v75, v75, v202
v_mul_f32_e64 v79, v79, v203
buffer_load_dwordx4 v[48:51], v4, s[12:15], s87 offen
v_mul_f32_e64 v83, v83, v204
v_mul_f32_e64 v87, v87, v205
v_mul_f32_e64 v91, v91, v206
s_waitcnt vmcnt(5)
v_mul_f32_e32 v95, v95, v207
v_cvt_pk_bf16_f32 v28, v67, v71
buffer_load_dwordx4 v[52:55], v4, s[12:15], s88 offen
v_cvt_pk_bf16_f32 v29, v75, v79
v_cvt_pk_bf16_f32 v30, v83, v87
v_cvt_pk_bf16_f32 v31, v91, v95
ds_write_b128 v6, v[20:23] offset:28928
ds_write_b128 v6, v[24:27] offset:28800
ds_write_b128 v6, v[28:31] offset:29056
v_fma_mix_f32 v96, v96, v208, -v212 op_sel_hi:[1,0,0]
v_fma_mix_f32 v100, v100, v208, -v212 op_sel_hi:[1,0,0]
v_fma_mix_f32 v104, v104, v208, -v212 op_sel_hi:[1,0,0]
buffer_load_dwordx4 v[56:59], v4, s[12:15], s89 offen
v_fma_mix_f32 v108, v108, v208, -v212 op_sel_hi:[1,0,0]
v_fma_mix_f32 v112, v112, v208, -v212 op_sel_hi:[1,0,0]
v_fma_mix_f32 v116, v116, v208, -v212 op_sel_hi:[1,0,0]
s_waitcnt lgkmcnt(0)
s_barrier
v_fma_mix_f32 v120, v120, v208, -v212 op_sel_hi:[1,0,0]
v_fma_mix_f32 v124, v124, v208, -v212 op_sel_hi:[1,0,0]
buffer_load_dwordx4 v[60:63], v4, s[12:15], s90 offen
v_mul_f32_e64 v96, v96, v216
v_mul_f32_e64 v100, v100, v217
v_mul_f32_e64 v104, v104, v218
v_mul_f32_e64 v108, v108, v219
v_mul_f32_e64 v112, v112, v220
v_mul_f32_e64 v116, v116, v221
v_mul_f32_e64 v120, v120, v222
v_mul_f32_e64 v124, v124, v223
v_cvt_pk_bf16_f32 v16, v96, v100
v_cvt_pk_bf16_f32 v17, v104, v108
v_cvt_pk_bf16_f32 v18, v112, v116
v_cvt_pk_bf16_f32 v19, v120, v124
ds_write_b128 v6, v[16:19] offset:12288
v_fma_mix_f32 v97, v97, v209, -v213 op_sel_hi:[1,0,0]
v_fma_mix_f32 v101, v101, v209, -v213 op_sel_hi:[1,0,0]
v_fma_mix_f32 v105, v105, v209, -v213 op_sel_hi:[1,0,0]
v_fma_mix_f32 v109, v109, v209, -v213 op_sel_hi:[1,0,0]
v_fma_mix_f32 v113, v113, v209, -v213 op_sel_hi:[1,0,0]
v_fma_mix_f32 v117, v117, v209, -v213 op_sel_hi:[1,0,0]
v_fma_mix_f32 v121, v121, v209, -v213 op_sel_hi:[1,0,0]
v_fma_mix_f32 v125, v125, v209, -v213 op_sel_hi:[1,0,0]
v_mul_f32_e64 v97, v97, v216
v_mul_f32_e64 v101, v101, v217
v_mul_f32_e64 v105, v105, v218
v_mul_f32_e64 v109, v109, v219
v_mul_f32_e64 v113, v113, v220
v_mul_f32_e64 v117, v117, v221
v_mul_f32_e64 v121, v121, v222
v_mul_f32_e64 v125, v125, v223
v_cvt_pk_bf16_f32 v20, v97, v101
v_cvt_pk_bf16_f32 v21, v105, v109
v_cvt_pk_bf16_f32 v22, v113, v117
v_cvt_pk_bf16_f32 v23, v121, v125
v_fma_mix_f32 v98, v98, v210, -v214 op_sel_hi:[1,0,0]
v_fma_mix_f32 v102, v102, v210, -v214 op_sel_hi:[1,0,0]
v_fma_mix_f32 v106, v106, v210, -v214 op_sel_hi:[1,0,0]
v_fma_mix_f32 v110, v110, v210, -v214 op_sel_hi:[1,0,0]
v_fma_mix_f32 v114, v114, v210, -v214 op_sel_hi:[1,0,0]
v_fma_mix_f32 v118, v118, v210, -v214 op_sel_hi:[1,0,0]
v_fma_mix_f32 v122, v122, v210, -v214 op_sel_hi:[1,0,0]
v_fma_mix_f32 v126, v126, v210, -v214 op_sel_hi:[1,0,0]
v_mul_f32_e64 v98, v98, v216
v_mul_f32_e64 v102, v102, v217
v_mul_f32_e64 v106, v106, v218
v_mul_f32_e64 v110, v110, v219
v_mul_f32_e64 v114, v114, v220
v_mul_f32_e64 v118, v118, v221
v_mul_f32_e64 v122, v122, v222
v_mul_f32_e64 v126, v126, v223
v_cvt_pk_bf16_f32 v24, v98, v102
v_cvt_pk_bf16_f32 v25, v106, v110
v_cvt_pk_bf16_f32 v26, v114, v118
v_cvt_pk_bf16_f32 v27, v122, v126
v_fma_mix_f32 v99, v99, v211, -v215 op_sel_hi:[1,0,0]
v_fma_mix_f32 v103, v103, v211, -v215 op_sel_hi:[1,0,0]
v_fma_mix_f32 v107, v107, v211, -v215 op_sel_hi:[1,0,0]
v_fma_mix_f32 v111, v111, v211, -v215 op_sel_hi:[1,0,0]
v_fma_mix_f32 v115, v115, v211, -v215 op_sel_hi:[1,0,0]
v_fma_mix_f32 v119, v119, v211, -v215 op_sel_hi:[1,0,0]
v_fma_mix_f32 v123, v123, v211, -v215 op_sel_hi:[1,0,0]
v_fma_mix_f32 v127, v127, v211, -v215 op_sel_hi:[1,0,0]
v_mul_f32_e64 v99, v99, v216
v_mul_f32_e64 v103, v103, v217
v_mul_f32_e64 v107, v107, v218
v_mul_f32_e64 v111, v111, v219
v_mul_f32_e64 v115, v115, v220
v_mul_f32_e64 v119, v119, v221
v_mul_f32_e64 v123, v123, v222
s_waitcnt vmcnt(0)
v_mul_f32_e32 v127, v127, v223
v_cvt_pk_bf16_f32 v28, v99, v103
v_cvt_pk_bf16_f32 v29, v107, v111
v_cvt_pk_bf16_f32 v30, v115, v119
v_cvt_pk_bf16_f32 v31, v123, v127
ds_write_b128 v6, v[20:23] offset:12544
ds_write_b128 v6, v[24:27] offset:12416
ds_write_b128 v6, v[28:31] offset:12672
v_fma_mix_f32 v32, v32, v224, -v228 op_sel_hi:[1,0,0]
v_fma_mix_f32 v36, v36, v224, -v228 op_sel_hi:[1,0,0]
v_fma_mix_f32 v40, v40, v224, -v228 op_sel_hi:[1,0,0]
v_fma_mix_f32 v44, v44, v224, -v228 op_sel_hi:[1,0,0]
v_fma_mix_f32 v48, v48, v224, -v228 op_sel_hi:[1,0,0]
v_fma_mix_f32 v52, v52, v224, -v228 op_sel_hi:[1,0,0]
s_waitcnt lgkmcnt(0)
s_barrier
v_fma_mix_f32 v56, v56, v224, -v228 op_sel_hi:[1,0,0]
v_fma_mix_f32 v60, v60, v224, -v228 op_sel_hi:[1,0,0]
v_mul_f32_e64 v32, v32, v232
v_mul_f32_e64 v36, v36, v233
v_mul_f32_e64 v40, v40, v234
v_mul_f32_e64 v44, v44, v235
v_mul_f32_e64 v48, v48, v236
v_mul_f32_e64 v52, v52, v237
v_mul_f32_e64 v56, v56, v238
v_mul_f32_e64 v60, v60, v239
v_cvt_pk_bf16_f32 v16, v32, v36
v_cvt_pk_bf16_f32 v17, v40, v44
v_cvt_pk_bf16_f32 v18, v48, v52
v_cvt_pk_bf16_f32 v19, v56, v60
ds_write_b128 v6, v[16:19] offset:28672
v_fma_mix_f32 v33, v33, v225, -v229 op_sel_hi:[1,0,0]
v_fma_mix_f32 v37, v37, v225, -v229 op_sel_hi:[1,0,0]
v_fma_mix_f32 v41, v41, v225, -v229 op_sel_hi:[1,0,0]
v_fma_mix_f32 v45, v45, v225, -v229 op_sel_hi:[1,0,0]
v_fma_mix_f32 v49, v49, v225, -v229 op_sel_hi:[1,0,0]
v_fma_mix_f32 v53, v53, v225, -v229 op_sel_hi:[1,0,0]
v_fma_mix_f32 v57, v57, v225, -v229 op_sel_hi:[1,0,0]
v_fma_mix_f32 v61, v61, v225, -v229 op_sel_hi:[1,0,0]
v_mul_f32_e64 v33, v33, v232
v_mul_f32_e64 v37, v37, v233
v_mul_f32_e64 v41, v41, v234
v_mul_f32_e64 v45, v45, v235
v_mul_f32_e64 v49, v49, v236
v_mul_f32_e64 v53, v53, v237
v_mul_f32_e64 v57, v57, v238
v_mul_f32_e64 v61, v61, v239
v_cvt_pk_bf16_f32 v20, v33, v37
v_cvt_pk_bf16_f32 v21, v41, v45
v_cvt_pk_bf16_f32 v22, v49, v53
v_cvt_pk_bf16_f32 v23, v57, v61
v_fma_mix_f32 v34, v34, v226, -v230 op_sel_hi:[1,0,0]
v_fma_mix_f32 v38, v38, v226, -v230 op_sel_hi:[1,0,0]
v_fma_mix_f32 v42, v42, v226, -v230 op_sel_hi:[1,0,0]
v_fma_mix_f32 v46, v46, v226, -v230 op_sel_hi:[1,0,0]
v_fma_mix_f32 v50, v50, v226, -v230 op_sel_hi:[1,0,0]
v_fma_mix_f32 v54, v54, v226, -v230 op_sel_hi:[1,0,0]
v_fma_mix_f32 v58, v58, v226, -v230 op_sel_hi:[1,0,0]
v_fma_mix_f32 v62, v62, v226, -v230 op_sel_hi:[1,0,0]
v_mul_f32_e64 v34, v34, v232
v_mul_f32_e64 v38, v38, v233
s_add_u32 m0, s33, 106496
s_add_u32 s23, s60, s39
buffer_load_dwordx4 v5, s[8:11], s23 offen   lds
v_mul_f32_e32 v42, v42, v234
v_mul_f32_e64 v46, v46, v235
v_mul_f32_e64 v50, v50, v236
v_mul_f32_e64 v54, v54, v237
v_mul_f32_e64 v58, v58, v238
v_mul_f32_e64 v62, v62, v239
s_add_u32 m0, s33, 110592
s_add_u32 s23, s60, s40
buffer_load_dwordx4 v5, s[8:11], s23 offen   lds
v_cvt_pk_bf16_f32 v24, v34, v38
v_cvt_pk_bf16_f32 v25, v42, v46
v_cvt_pk_bf16_f32 v26, v50, v54
v_cvt_pk_bf16_f32 v27, v58, v62
v_fma_mix_f32 v35, v35, v227, -v231 op_sel_hi:[1,0,0]
v_fma_mix_f32 v39, v39, v227, -v231 op_sel_hi:[1,0,0]
s_add_u32 m0, s33, 114688
s_add_u32 s23, s60, s41
buffer_load_dwordx4 v5, s[8:11], s23 offen   lds
v_fma_mix_f32 v43, v43, v227, -v231 op_sel_hi:[1,0,0]
v_fma_mix_f32 v47, v47, v227, -v231 op_sel_hi:[1,0,0]
v_fma_mix_f32 v51, v51, v227, -v231 op_sel_hi:[1,0,0]
v_fma_mix_f32 v55, v55, v227, -v231 op_sel_hi:[1,0,0]
v_fma_mix_f32 v59, v59, v227, -v231 op_sel_hi:[1,0,0]
v_fma_mix_f32 v63, v63, v227, -v231 op_sel_hi:[1,0,0]
s_add_u32 m0, s33, 118784
s_add_u32 s23, s60, s42
buffer_load_dwordx4 v5, s[8:11], s23 offen   lds
v_mul_f32_e32 v35, v35, v232
v_mul_f32_e64 v39, v39, v233
v_mul_f32_e64 v43, v43, v234
v_mul_f32_e64 v47, v47, v235
v_mul_f32_e64 v51, v51, v236
v_mul_f32_e64 v55, v55, v237
s_add_u32 m0, s33, 122880
s_cmp_eq_u32 s27, 0
s_cselect_b32 s23, s60, s61
s_add_u32 s23, s23, s43
buffer_load_dwordx4 v5, s[8:11], s23 offen   lds
v_mul_f32_e32 v59, v59, v238
v_mul_f32_e64 v63, v63, v239
v_cvt_pk_bf16_f32 v28, v35, v39
v_cvt_pk_bf16_f32 v29, v43, v47
v_cvt_pk_bf16_f32 v30, v51, v55
v_cvt_pk_bf16_f32 v31, v59, v63
ds_write_b128 v6, v[20:23] offset:28928
ds_write_b128 v6, v[24:27] offset:28800
ds_write_b128 v6, v[28:31] offset:29056
s_waitcnt lgkmcnt(0)
s_barrier
s_add_u32 m0, s33, 126976
s_add_u32 s23, s61, s44
buffer_load_dwordx4 v5, s[8:11], s23 offen   lds
s_add_u32 m0, s33, 131072
s_add_u32 s23, s61, s45
buffer_load_dwordx4 v5, s[8:11], s23 offen   lds
s_add_u32 m0, s33, 135168
s_add_u32 s23, s61, s46
buffer_load_dwordx4 v5, s[8:11], s23 offen   lds
s_add_u32 m0, s33, 139264
s_add_u32 s23, s61, s47
buffer_load_dwordx4 v5, s[8:11], s23 offen   lds
s_waitcnt vmcnt(4)
s_waitcnt lgkmcnt(0)
s_barrier
ds_read2st64_b64 v[96:99], v9 offset0:0 offset1:4
s_add_u32 m0, s33, 143360
s_add_u32 s23, s62, s39
buffer_load_dwordx4 v5, s[8:11], s23 offen   lds
ds_read2st64_b64 v[100:103], v9 offset0:8 offset1:12
s_mov_b32 s23, 0
s_waitcnt lgkmcnt(1)
buffer_store_dwordx4 v[96:99], v10, s[28:31], s23 offen nt
s_add_u32 m0, s33, 147456
s_add_u32 s23, s62, s40
buffer_load_dwordx4 v5, s[8:11], s23 offen   lds
s_mov_b32 s23, 147456
s_waitcnt lgkmcnt(0)
buffer_store_dwordx4 v[100:103], v10, s[28:31], s23 offen nt
s_add_u32 m0, s33, 151552
s_add_u32 s23, s62, s41
buffer_load_dwordx4 v5, s[8:11], s23 offen   lds
s_add_u32 m0, s33, 155648
s_add_u32 s23, s62, s42
buffer_load_dwordx4 v5, s[8:11], s23 offen   lds
s_add_u32 m0, s33, 159744
s_cmp_eq_u32 s27, 0
s_cselect_b32 s23, s62, s63
s_add_u32 s23, s23, s43
buffer_load_dwordx4 v5, s[8:11], s23 offen   lds
s_add_u32 m0, s33, 45056
s_add_u32 s23, s63, s44
buffer_load_dwordx4 v5, s[8:11], s23 offen   lds
s_waitcnt vmcnt(8)
s_waitcnt lgkmcnt(0)
s_barrier
ds_read2st64_b64 v[104:107], v9 offset0:16 offset1:20
s_add_u32 m0, s33, 49152
s_add_u32 s23, s63, s45
L_pad1:
s_cmp_eq_u32 s57, 1
s_cbranch_scc1 L_wret
buffer_load_dwordx4 v5, s[8:11], s23 offen   lds
s_mov_b32 s23, 294912
s_waitcnt lgkmcnt(0)
buffer_store_dwordx4 v[104:107], v10, s[28:31], s23 offen nt
s_add_u32 m0, s33, 53248
s_add_u32 s23, s63, s46
buffer_load_dwordx4 v5, s[8:11], s23 offen   lds
s_add_u32 m0, s33, 57344
s_add_u32 s23, s63, s47
buffer_load_dwordx4 v5, s[8:11], s23 offen   lds
s_add_u32 m0, s33, 61440
s_add_u32 s23, s64, s39
buffer_load_dwordx4 v5, s[8:11], s23 offen   lds
s_add_u32 m0, s33, 65536
s_add_u32 s23, s64, s40
buffer_load_dwordx4 v5, s[8:11], s23 offen   lds
s_waitcnt vmcnt(7)
s_waitcnt lgkmcnt(0)
s_barrier
ds_read2st64_b64 v[108:111], v9 offset0:24 offset1:28
s_add_u32 m0, s33, 69632
s_add_u32 s23, s64, s41
buffer_load_dwordx4 v5, s[8:11], s23 offen   lds
s_lshl_b32 s23, s60, 3
s_waitcnt lgkmcnt(0)
buffer_store_dwordx4 v[108:111], v10, s[28:31], s23 offen nt
s_add_u32 m0, s33, 73728
s_add_u32 s23, s64, s42
buffer_load_dwordx4 v5, s[8:11], s23 offen   lds
s_add_u32 m0, s33, 77824
s_cmp_eq_u32 s27, 0
s_cselect_b32 s23, s64, s65
s_add_u32 s23, s23, s43
buffer_load_dwordx4 v5, s[8:11], s23 offen   lds
s_add_u32 m0, s33, 81920
s_add_u32 s23, s65, s44
buffer_load_dwordx4 v5, s[8:11], s23 offen   lds
s_add_u32 m0, s33, 86016
s_add_u32 s23, s65, s45
buffer_load_dwordx4 v5, s[8:11], s23 offen   lds
s_waitcnt vmcnt(8)
s_waitcnt lgkmcnt(0)
s_barrier
ds_read2st64_b64 v[112:115], v9 offset0:32 offset1:36
s_add_u32 m0, s33, 90112
s_add_u32 s23, s65, s46
buffer_load_dwordx4 v5, s[8:11], s23 offen   lds
s_lshl_b32 s23, s61, 3
s_waitcnt lgkmcnt(0)
buffer_store_dwordx4 v[112:115], v10, s[28:31], s23 offen nt
s_add_u32 m0, s33, 94208
s_add_u32 s23, s65, s47
buffer_load_dwordx4 v5, s[8:11], s23 offen   lds
s_add_u32 m0, s33, 98304
s_add_u32 s23, s66, s39
buffer_load_dwordx4 v5, s[8:11], s23 offen   lds
s_add_u32 m0, s33, 102400
s_add_u32 s23, s66, s40
buffer_load_dwordx4 v5, s[8:11], s23 offen   lds
s_add_u32 m0, s33, 106496
s_add_u32 s23, s66, s41
buffer_load_dwordx4 v5, s[8:11], s23 offen   lds
s_waitcnt vmcnt(8)
s_waitcnt lgkmcnt(0)
s_barrier
ds_read2st64_b64 v[116:119], v9 offset0:40 offset1:44
s_add_u32 m0, s33, 110592
s_add_u32 s23, s66, s42
buffer_load_dwordx4 v5, s[8:11], s23 offen   lds
ds_read2st64_b64 v[120:123], v9 offset0:48 offset1:52
s_lshl_b32 s23, s62, 3
s_waitcnt lgkmcnt(1)
buffer_store_dwordx4 v[116:119], v10, s[28:31], s23 offen nt
s_add_u32 m0, s33, 114688
s_cmp_eq_u32 s27, 0
s_cselect_b32 s23, s66, s67
s_add_u32 s23, s23, s43
buffer_load_dwordx4 v5, s[8:11], s23 offen   lds
s_mov_b32 s23, 442368
s_waitcnt lgkmcnt(0)
buffer_store_dwordx4 v[120:123], v10, s[28:31], s23 offen nt
s_add_u32 m0, s33, 118784
s_add_u32 s23, s67, s44
buffer_load_dwordx4 v5, s[8:11], s23 offen   lds
s_add_u32 m0, s33, 122880
s_add_u32 s23, s67, s45
buffer_load_dwordx4 v5, s[8:11], s23 offen   lds
s_add_u32 m0, s33, 126976
s_add_u32 s23, s67, s46
buffer_load_dwordx4 v5, s[8:11], s23 offen   lds
s_waitcnt vmcnt(10)
s_waitcnt lgkmcnt(0)
s_barrier
ds_read2st64_b64 v[124:127], v9 offset0:56 offset1:60
s_add_u32 m0, s33, 131072
s_add_u32 s23, s67, s47
buffer_load_dwordx4 v5, s[8:11], s23 offen   lds
ds_read2st64_b64 v[128:131], v9 offset0:64 offset1:68
ds_read2st64_b64 v[132:135], v9 offset0:72 offset1:76
s_lshl_b32 s23, s63, 3
s_waitcnt lgkmcnt(2)
buffer_store_dwordx4 v[124:127], v10, s[28:31], s23 offen nt
s_add_u32 m0, s33, 135168
s_add_u32 s23, s68, s39
buffer_load_dwordx4 v5, s[8:11], s23 offen   lds
s_mov_b32 s23, 589824
s_waitcnt lgkmcnt(1)
buffer_store_dwordx4 v[128:131], v10, s[28:31], s23 offen nt
s_add_u32 m0, s33, 139264
s_add_u32 s23, s68, s40
buffer_load_dwordx4 v5, s[8:11], s23 offen   lds
s_mov_b32 s23, 737280
s_waitcnt lgkmcnt(0)
buffer_store_dwordx4 v[132:135], v10, s[28:31], s23 offen nt
s_add_u32 m0, s33, 143360
s_add_u32 s23, s68, s41
buffer_load_dwordx4 v5, s[8:11], s23 offen   lds
s_add_u32 m0, s33, 147456
s_add_u32 s23, s68, s42
buffer_load_dwordx4 v5, s[8:11], s23 offen   lds
s_waitcnt vmcnt(12)
s_waitcnt lgkmcnt(0)
s_barrier
ds_read2st64_b64 v[136:139], v9 offset0:80 offset1:84
s_add_u32 m0, s33, 151552
s_cmp_eq_u32 s27, 0
s_cselect_b32 s23, s68, 0x10000000
s_add_u32 s23, s23, s43
buffer_load_dwordx4 v5, s[8:11], s23 offen   lds
ds_read2st64_b64 v[140:143], v9 offset0:0 offset1:4
ds_read2st64_b64 v[144:147], v9 offset0:8 offset1:12
s_lshl_b32 s23, s64, 3
s_waitcnt lgkmcnt(2)
buffer_store_dwordx4 v[136:139], v10, s[28:31], s23 offen nt
s_mov_b32 s23, 884736
s_waitcnt lgkmcnt(1)
buffer_store_dwordx4 v[140:143], v10, s[28:31], s23 offen nt
s_mov_b32 s23, 1032192
s_waitcnt lgkmcnt(0)
buffer_store_dwordx4 v[144:147], v10, s[28:31], s23 offen nt
s_waitcnt vmcnt(11)
s_waitcnt lgkmcnt(0)
s_barrier
ds_read2st64_b64 v[148:151], v9 offset0:16 offset1:20
ds_read2st64_b64 v[152:155], v9 offset0:24 offset1:28
ds_read2st64_b64 v[156:159], v9 offset0:32 offset1:36
s_lshl_b32 s23, s65, 3
s_waitcnt lgkmcnt(2)
buffer_store_dwordx4 v[148:151], v10, s[28:31], s23 offen nt
s_mov_b32 s23, 1179648
s_waitcnt lgkmcnt(1)
buffer_store_dwordx4 v[152:155], v10, s[28:31], s23 offen nt
s_mov_b32 s23, 1327104
s_waitcnt lgkmcnt(0)
buffer_store_dwordx4 v[156:159], v10, s[28:31], s23 offen nt
s_cmp_lt_u32 s6, 2
s_cbranch_scc0 L_p18
s_waitcnt vmcnt(6)
s_waitcnt lgkmcnt(0)
s_barrier
ds_read2st64_b64 v[96:99], v9 offset0:40 offset1:44
s_lshl_b32 s23, s66, 3
s_waitcnt lgkmcnt(0)
buffer_store_dwordx4 v[96:99], v10, s[28:31], s23 offen nt
s_waitcnt lgkmcnt(0)
s_barrier
ds_read2st64_b64 v[100:103], v9 offset0:48 offset1:52
s_lshl_b32 s23, s67, 3
s_waitcnt lgkmcnt(0)
buffer_store_dwordx4 v[100:103], v10, s[28:31], s23 offen nt
s_waitcnt lgkmcnt(0)
s_barrier
ds_read2st64_b64 v[104:107], v9 offset0:56 offset1:60
s_lshl_b32 s23, s68, 3
s_waitcnt lgkmcnt(0)
buffer_store_dwordx4 v[104:107], v10, s[28:31], s23 offen nt
s_endpgm
.p2align 12
L_cmain:
s_waitcnt vmcnt(5)
s_barrier
ds_read_b128 v[112:115], v4 offset:28672
ds_read_b128 v[116:119], v4 offset:28928
ds_read_b128 v[8:11], v0 offset:0
ds_read_b128 v[120:123], v4 offset:36864
ds_read_b128 v[124:127], v4 offset:37120
ds_read_b128 v[12:15], v0 offset:2048
ds_read_b128 v[16:19], v0 offset:4096
s_waitcnt lgkmcnt(4)
v_mfma_f32_16x16x32_bf16 v[24:27], v[112:115], v[8:11], 0
ds_read_b128 v[20:23], v0 offset:6144
v_mfma_f32_16x16x32_bf16 v[28:31], v[116:119], v[8:11], 0
s_waitcnt lgkmcnt(2)
v_mfma_f32_16x16x32_bf16 v[32:35], v[112:115], v[12:15], 0
ds_read_b128 v[8:11], v0 offset:8192
v_mfma_f32_16x16x32_bf16 v[36:39], v[116:119], v[12:15], 0
s_waitcnt lgkmcnt(2)
v_mfma_f32_16x16x32_bf16 v[40:43], v[112:115], v[16:19], 0
ds_read_b128 v[12:15], v0 offset:10240
v_mfma_f32_16x16x32_bf16 v[44:47], v[116:119], v[16:19], 0
s_waitcnt lgkmcnt(2)
v_mfma_f32_16x16x32_bf16 v[48:51], v[112:115], v[20:23], 0
ds_read_b128 v[16:19], v0 offset:12288
v_mfma_f32_16x16x32_bf16 v[52:55], v[116:119], v[20:23], 0
s_waitcnt lgkmcnt(2)
v_mfma_f32_16x16x32_bf16 v[56:59], v[112:115], v[8:11], 0
ds_read_b128 v[20:23], v0 offset:14336
v_mfma_f32_16x16x32_bf16 v[60:63], v[116:119], v[8:11], 0
s_waitcnt lgkmcnt(2)
v_mfma_f32_16x16x32_bf16 v[64:67], v[112:115], v[12:15], 0
ds_read_b128 v[8:11], v0 offset:16384
v_mfma_f32_16x16x32_bf16 v[68:71], v[116:119], v[12:15], 0
s_waitcnt lgkmcnt(2)
v_mfma_f32_16x16x32_bf16 v[72:75], v[112:115], v[16:19], 0
ds_read_b128 v[12:15], v0 offset:18432
v_mfma_f32_16x16x32_bf16 v[76:79], v[116:119], v[16:19], 0
s_waitcnt lgkmcnt(2)
v_mfma_f32_16x16x32_bf16 v[80:83], v[112:115], v[20:23], 0
ds_read_b128 v[16:19], v1 offset:0
v_mfma_f32_16x16x32_bf16 v[84:87], v[116:119], v[20:23], 0
s_waitcnt lgkmcnt(2)
v_mfma_f32_16x16x32_bf16 v[88:91], v[112:115], v[8:11], 0
ds_read_b128 v[20:23], v1 offset:2048
v_mfma_f32_16x16x32_bf16 v[92:95], v[116:119], v[8:11], 0
s_waitcnt lgkmcnt(2)
v_mfma_f32_16x16x32_bf16 v[96:99], v[112:115], v[12:15], 0
ds_read_b128 v[8:11], v1 offset:4096
v_mfma_f32_16x16x32_bf16 v[100:103], v[116:119], v[12:15], 0
s_waitcnt lgkmcnt(2)
v_mfma_f32_16x16x32_bf16 v[24:27], v[120:123], v[16:19], v[24:27]
ds_read_b128 v[12:15], v1 offset:6144
v_mfma_f32_16x16x32_bf16 v[28:31], v[124:127], v[16:19], v[28:31]
s_waitcnt lgkmcnt(2)
v_mfma_f32_16x16x32_bf16 v[32:35], v[120:123], v[20:23], v[32:35]
ds_read_b128 v[16:19], v1 offset:8192
v_mfma_f32_16x16x32_bf16 v[36:39], v[124:127], v[20:23], v[36:39]
s_waitcnt lgkmcnt(2)
v_mfma_f32_16x16x32_bf16 v[40:43], v[120:123], v[8:11], v[40:43]
ds_read_b128 v[20:23], v1 offset:10240
v_mfma_f32_16x16x32_bf16 v[44:47], v[124:127], v[8:11], v[44:47]
s_waitcnt lgkmcnt(2)
v_mfma_f32_16x16x32_bf16 v[48:51], v[120:123], v[12:15], v[48:51]
ds_read_b128 v[8:11], v1 offset:12288
v_mfma_f32_16x16x32_bf16 v[52:55], v[124:127], v[12:15], v[52:55]
s_waitcnt lgkmcnt(2)
v_mfma_f32_16x16x32_bf16 v[56:59], v[120:123], v[16:19], v[56:59]
ds_read_b128 v[12:15], v1 offset:14336
v_mfma_f32_16x16x32_bf16 v[60:63], v[124:127], v[16:19], v[60:63]
s_waitcnt lgkmcnt(2)
v_mfma_f32_16x16x32_bf16 v[64:67], v[120:123], v[20:23], v[64:67]
ds_read_b128 v[16:19], v1 offset:16384
v_mfma_f32_16x16x32_bf16 v[68:71], v[124:127], v[20:23], v[68:71]
s_waitcnt lgkmcnt(2)
v_mfma_f32_16x16x32_bf16 v[72:75], v[120:123], v[8:11], v[72:75]
s_waitcnt vmcnt(0)
s_barrier
ds_read_b128 v[20:23], v1 offset:18432
ds_read_b128 v[128:131], v4 offset:12288
v_mfma_f32_16x16x32_bf16 v[76:79], v[124:127], v[8:11], v[76:79]
s_waitcnt lgkmcnt(3)
ds_read_b128 v[132:135], v4 offset:12544
v_mfma_f32_16x16x32_bf16 v[80:83], v[120:123], v[12:15], v[80:83]
ds_read_b128 v[8:11], v0 offset:20480
ds_read_b128 v[136:139], v4 offset:20480
v_mfma_f32_16x16x32_bf16 v[84:87], v[124:127], v[12:15], v[84:87]
s_waitcnt lgkmcnt(5)
ds_read_b128 v[140:143], v4 offset:20736
v_mfma_f32_16x16x32_bf16 v[88:91], v[120:123], v[16:19], v[88:91]
ds_read_b128 v[12:15], v0 offset:22528
s_add_u32 m0, s33, 86016
v_mfma_f32_16x16x32_bf16 v[92:95], v[124:127], v[16:19], v[92:95]
s_waitcnt lgkmcnt(6)
s_add_u32 s35, s31, s32
v_mfma_f32_16x16x32_bf16 v[96:99], v[120:123], v[20:23], v[96:99]
ds_read_b128 v[16:19], v0 offset:24576
buffer_load_dwordx4 v6, s[8:11], s35 offen   lds
v_mfma_f32_16x16x32_bf16 v[100:103], v[124:127], v[20:23], v[100:103]
s_waitcnt lgkmcnt(4)
s_add_u32 m0, s33, 90112
v_mfma_f32_16x16x32_bf16 v[24:27], v[128:131], v[8:11], v[24:27]
ds_read_b128 v[20:23], v0 offset:26624
s_add_u32 s35, s35, 36864
v_mfma_f32_16x16x32_bf16 v[28:31], v[132:135], v[8:11], v[28:31]
s_waitcnt lgkmcnt(2)
buffer_load_dwordx4 v6, s[8:11], s35 offen   lds
v_mfma_f32_16x16x32_bf16 v[32:35], v[128:131], v[12:15], v[32:35]
ds_read_b128 v[8:11], v0 offset:28672
s_add_u32 m0, s33, 94208
v_mfma_f32_16x16x32_bf16 v[36:39], v[132:135], v[12:15], v[36:39]
s_waitcnt lgkmcnt(2)
s_add_u32 s35, s35, 36864
v_mfma_f32_16x16x32_bf16 v[40:43], v[128:131], v[16:19], v[40:43]
ds_read_b128 v[12:15], v0 offset:30720
buffer_load_dwordx4 v6, s[8:11], s35 offen   lds
v_mfma_f32_16x16x32_bf16 v[44:47], v[132:135], v[16:19], v[44:47]
s_waitcnt lgkmcnt(2)
s_add_u32 m0, s33, 98304
v_mfma_f32_16x16x32_bf16 v[48:51], v[128:131], v[20:23], v[48:51]
ds_read_b128 v[16:19], v0 offset:32768
s_add_u32 s35, s35, 36864
v_mfma_f32_16x16x32_bf16 v[52:55], v[132:135], v[20:23], v[52:55]
s_waitcnt lgkmcnt(2)
buffer_load_dwordx4 v6, s[8:11], s35 offen   lds
v_mfma_f32_16x16x32_bf16 v[56:59], v[128:131], v[8:11], v[56:59]
ds_read_b128 v[20:23], v0 offset:34816
s_add_u32 m0, s33, 102400
v_mfma_f32_16x16x32_bf16 v[60:63], v[132:135], v[8:11], v[60:63]
s_waitcnt lgkmcnt(2)
s_add_u32 s35, s35, 36864
v_mfma_f32_16x16x32_bf16 v[64:67], v[128:131], v[12:15], v[64:67]
ds_read_b128 v[8:11], v0 offset:36864
buffer_load_dwordx4 v6, s[8:11], s35 offen   lds
v_mfma_f32_16x16x32_bf16 v[68:71], v[132:135], v[12:15], v[68:71]
s_waitcnt lgkmcnt(2)
s_add_u32 s31, s31, 128
v_mfma_f32_16x16x32_bf16 v[72:75], v[128:131], v[16:19], v[72:75]
ds_read_b128 v[12:15], v0 offset:38912
s_cmp_eq_u32 s31, 1152
s_cselect_b32 s31, 0, s31
v_mfma_f32_16x16x32_bf16 v[76:79], v[132:135], v[16:19], v[76:79]
s_waitcnt lgkmcnt(2)
v_mfma_f32_16x16x32_bf16 v[80:83], v[128:131], v[20:23], v[80:83]
ds_read_b128 v[16:19], v1 offset:20480
v_mfma_f32_16x16x32_bf16 v[84:87], v[132:135], v[20:23], v[84:87]
s_waitcnt lgkmcnt(2)
v_mfma_f32_16x16x32_bf16 v[88:91], v[128:131], v[8:11], v[88:91]
ds_read_b128 v[20:23], v1 offset:22528
v_mfma_f32_16x16x32_bf16 v[92:95], v[132:135], v[8:11], v[92:95]
s_waitcnt lgkmcnt(2)
v_mfma_f32_16x16x32_bf16 v[96:99], v[128:131], v[12:15], v[96:99]
ds_read_b128 v[8:11], v1 offset:24576
v_mfma_f32_16x16x32_bf16 v[100:103], v[132:135], v[12:15], v[100:103]
s_waitcnt lgkmcnt(2)
v_mfma_f32_16x16x32_bf16 v[24:27], v[136:139], v[16:19], v[24:27]
ds_read_b128 v[12:15], v1 offset:26624
v_mfma_f32_16x16x32_bf16 v[28:31], v[140:143], v[16:19], v[28:31]
s_waitcnt lgkmcnt(2)
v_mfma_f32_16x16x32_bf16 v[32:35], v[136:139], v[20:23], v[32:35]
ds_read_b128 v[16:19], v1 offset:28672
v_mfma_f32_16x16x32_bf16 v[36:39], v[140:143], v[20:23], v[36:39]
s_waitcnt lgkmcnt(2)
v_mfma_f32_16x16x32_bf16 v[40:43], v[136:139], v[8:11], v[40:43]
ds_read_b128 v[20:23], v1 offset:30720
v_mfma_f32_16x16x32_bf16 v[44:47], v[140:143], v[8:11], v[44:47]
s_waitcnt lgkmcnt(2)
v_mfma_f32_16x16x32_bf16 v[48:51], v[136:139], v[12:15], v[48:51]
ds_read_b128 v[8:11], v1 offset:32768
v_mfma_f32_16x16x32_bf16 v[52:55], v[140:143], v[12:15], v[52:55]
s_waitcnt lgkmcnt(2)
v_mfma_f32_16x16x32_bf16 v[56:59], v[136:139], v[16:19], v[56:59]
ds_read_b128 v[12:15], v1 offset:34816
v_mfma_f32_16x16x32_bf16 v[60:63], v[140:143], v[16:19], v[60:63]
s_waitcnt lgkmcnt(2)
v_mfma_f32_16x16x32_bf16 v[64:67], v[136:139], v[20:23], v[64:67]
ds_read_b128 v[16:19], v1 offset:36864
v_mfma_f32_16x16x32_bf16 v[68:71], v[140:143], v[20:23], v[68:71]
s_waitcnt lgkmcnt(2)
v_mfma_f32_16x16x32_bf16 v[72:75], v[136:139], v[8:11], v[72:75]
s_waitcnt vmcnt(0)
s_barrier
ds_read_b128 v[20:23], v1 offset:38912
ds_read_b128 v[144:147], v4 offset:28672
v_mfma_f32_16x16x32_bf16 v[76:79], v[140:143], v[8:11], v[76:79]
s_waitcnt lgkmcnt(3)
ds_read_b128 v[148:151], v4 offset:28928
v_mfma_f32_16x16x32_bf16 v[80:83], v[136:139], v[12:15], v[80:83]
ds_read_b128 v[8:11], v0 offset:40960
ds_read_b128 v[152:155], v4 offset:36864
v_mfma_f32_16x16x32_bf16 v[84:87], v[140:143], v[12:15], v[84:87]
s_waitcnt lgkmcnt(5)
ds_read_b128 v[156:159], v4 offset:37120
v_mfma_f32_16x16x32_bf16 v[88:91], v[136:139], v[16:19], v[88:91]
ds_read_b128 v[12:15], v0 offset:43008
s_add_u32 m0, s33, 45056
v_mfma_f32_16x16x32_bf16 v[92:95], v[140:143], v[16:19], v[92:95]
s_waitcnt lgkmcnt(6)
s_add_u32 s35, s31, s32
v_mfma_f32_16x16x32_bf16 v[96:99], v[136:139], v[20:23], v[96:99]
ds_read_b128 v[16:19], v0 offset:45056
buffer_load_dwordx4 v6, s[8:11], s35 offen   lds
v_mfma_f32_16x16x32_bf16 v[100:103], v[140:143], v[20:23], v[100:103]
s_waitcnt lgkmcnt(4)
s_add_u32 m0, s33, 49152
v_mfma_f32_16x16x32_bf16 v[24:27], v[144:147], v[8:11], v[24:27]
ds_read_b128 v[20:23], v0 offset:47104
s_add_u32 s35, s35, 36864
v_mfma_f32_16x16x32_bf16 v[28:31], v[148:151], v[8:11], v[28:31]
s_waitcnt lgkmcnt(2)
buffer_load_dwordx4 v6, s[8:11], s35 offen   lds
v_mfma_f32_16x16x32_bf16 v[32:35], v[144:147], v[12:15], v[32:35]
ds_read_b128 v[8:11], v0 offset:49152
s_add_u32 m0, s33, 53248
v_mfma_f32_16x16x32_bf16 v[36:39], v[148:151], v[12:15], v[36:39]
s_waitcnt lgkmcnt(2)
s_add_u32 s35, s35, 36864
v_mfma_f32_16x16x32_bf16 v[40:43], v[144:147], v[16:19], v[40:43]
ds_read_b128 v[12:15], v0 offset:51200
buffer_load_dwordx4 v6, s[8:11], s35 offen   lds
v_mfma_f32_16x16x32_bf16 v[44:47], v[148:151], v[16:19], v[44:47]
s_waitcnt lgkmcnt(2)
s_add_u32 m0, s33, 57344
v_mfma_f32_16x16x32_bf16 v[48:51], v[144:147], v[20:23], v[48:51]
ds_read_b128 v[16:19], v0 offset:53248
s_add_u32 s35, s35, 36864
v_mfma_f32_16x16x32_bf16 v[52:55], v[148:151], v[20:23], v[52:55]
s_waitcnt lgkmcnt(2)
buffer_load_dwordx4 v6, s[8:11], s35 offen   lds
v_mfma_f32_16x16x32_bf16 v[56:59], v[144:147], v[8:11], v[56:59]
ds_read_b128 v[20:23], v0 offset:55296
s_add_u32 m0, s33, 61440
v_mfma_f32_16x16x32_bf16 v[60:63], v[148:151], v[8:11], v[60:63]
s_waitcnt lgkmcnt(2)
s_add_u32 s35, s35, 36864
v_mfma_f32_16x16x32_bf16 v[64:67], v[144:147], v[12:15], v[64:67]
ds_read_b128 v[8:11], v0 offset:57344
buffer_load_dwordx4 v6, s[8:11], s35 offen   lds
v_mfma_f32_16x16x32_bf16 v[68:71], v[148:151], v[12:15], v[68:71]
s_waitcnt lgkmcnt(2)
s_add_u32 s31, s31, 128
v_mfma_f32_16x16x32_bf16 v[72:75], v[144:147], v[16:19], v[72:75]
ds_read_b128 v[12:15], v0 offset:59392
s_cmp_eq_u32 s31, 1152
s_cselect_b32 s31, 0, s31
v_mfma_f32_16x16x32_bf16 v[76:79], v[148:151], v[16:19], v[76:79]
s_waitcnt lgkmcnt(2)
v_mfma_f32_16x16x32_bf16 v[80:83], v[144:147], v[20:23], v[80:83]
ds_read_b128 v[16:19], v1 offset:40960
v_mfma_f32_16x16x32_bf16 v[84:87], v[148:151], v[20:23], v[84:87]
s_waitcnt lgkmcnt(2)
v_mfma_f32_16x16x32_bf16 v[88:91], v[144:147], v[8:11], v[88:91]
ds_read_b128 v[20:23], v1 offset:43008
v_mfma_f32_16x16x32_bf16 v[92:95], v[148:151], v[8:11], v[92:95]
s_waitcnt lgkmcnt(2)
v_mfma_f32_16x16x32_bf16 v[96:99], v[144:147], v[12:15], v[96:99]
ds_read_b128 v[8:11], v1 offset:45056
v_mfma_f32_16x16x32_bf16 v[100:103], v[148:151], v[12:15], v[100:103]
s_waitcnt lgkmcnt(2)
v_mfma_f32_16x16x32_bf16 v[24:27], v[152:155], v[16:19], v[24:27]
ds_read_b128 v[12:15], v1 offset:47104
v_mfma_f32_16x16x32_bf16 v[28:31], v[156:159], v[16:19], v[28:31]
s_waitcnt lgkmcnt(2)
v_mfma_f32_16x16x32_bf16 v[32:35], v[152:155], v[20:23], v[32:35]
ds_read_b128 v[16:19], v1 offset:49152
v_mfma_f32_16x16x32_bf16 v[36:39], v[156:159], v[20:23], v[36:39]
s_waitcnt lgkmcnt(2)
v_mfma_f32_16x16x32_bf16 v[40:43], v[152:155], v[8:11], v[40:43]
ds_read_b128 v[20:23], v1 offset:51200
v_mfma_f32_16x16x32_bf16 v[44:47], v[156:159], v[8:11], v[44:47]
s_waitcnt lgkmcnt(2)
v_mfma_f32_16x16x32_bf16 v[48:51], v[152:155], v[12:15], v[48:51]
ds_read_b128 v[8:11], v1 offset:53248
v_mfma_f32_16x16x32_bf16 v[52:55], v[156:159], v[12:15], v[52:55]
s_waitcnt lgkmcnt(2)
v_mfma_f32_16x16x32_bf16 v[56:59], v[152:155], v[16:19], v[56:59]
ds_read_b128 v[12:15], v1 offset:55296
v_mfma_f32_16x16x32_bf16 v[60:63], v[156:159], v[16:19], v[60:63]
s_waitcnt lgkmcnt(2)
v_mfma_f32_16x16x32_bf16 v[64:67], v[152:155], v[20:23], v[64:67]
ds_read_b128 v[16:19], v1 offset:57344
v_mfma_f32_16x16x32_bf16 v[68:71], v[156:159], v[20:23], v[68:71]
s_waitcnt lgkmcnt(2)
v_mfma_f32_16x16x32_bf16 v[72:75], v[152:155], v[8:11], v[72:75]
s_waitcnt vmcnt(0)
s_barrier
ds_read_b128 v[20:23], v1 offset:59392
ds_read_b128 v[160:163], v4 offset:12288
v_mfma_f32_16x16x32_bf16 v[76:79], v[156:159], v[8:11], v[76:79]
s_waitcnt lgkmcnt(3)
ds_read_b128 v[164:167], v4 offset:12544
v_mfma_f32_16x16x32_bf16 v[80:83], v[152:155], v[12:15], v[80:83]
ds_read_b128 v[8:11], v0 offset:0
ds_read_b128 v[168:171], v4 offset:20480
v_mfma_f32_16x16x32_bf16 v[84:87], v[156:159], v[12:15], v[84:87]
s_waitcnt lgkmcnt(5)
ds_read_b128 v[172:175], v4 offset:20736
v_mfma_f32_16x16x32_bf16 v[88:91], v[152:155], v[16:19], v[88:91]
ds_read_b128 v[12:15], v0 offset:2048
s_add_u32 m0, s33, 65536
v_mfma_f32_16x16x32_bf16 v[92:95], v[156:159], v[16:19], v[92:95]
s_waitcnt lgkmcnt(6)
s_add_u32 s35, s31, s32
v_mfma_f32_16x16x32_bf16 v[96:99], v[152:155], v[20:23], v[96:99]
ds_read_b128 v[16:19], v0 offset:4096
buffer_load_dwordx4 v6, s[8:11], s35 offen   lds
v_mfma_f32_16x16x32_bf16 v[100:103], v[156:159], v[20:23], v[100:103]
s_waitcnt lgkmcnt(4)
s_add_u32 m0, s33, 69632
v_mfma_f32_16x16x32_bf16 v[24:27], v[160:163], v[8:11], v[24:27]
ds_read_b128 v[20:23], v0 offset:6144
s_add_u32 s35, s35, 36864
v_mfma_f32_16x16x32_bf16 v[28:31], v[164:167], v[8:11], v[28:31]
s_waitcnt lgkmcnt(2)
buffer_load_dwordx4 v6, s[8:11], s35 offen   lds
v_mfma_f32_16x16x32_bf16 v[32:35], v[160:163], v[12:15], v[32:35]
ds_read_b128 v[8:11], v0 offset:8192
s_add_u32 m0, s33, 73728
v_mfma_f32_16x16x32_bf16 v[36:39], v[164:167], v[12:15], v[36:39]
s_waitcnt lgkmcnt(2)
s_add_u32 s35, s35, 36864
v_mfma_f32_16x16x32_bf16 v[40:43], v[160:163], v[16:19], v[40:43]
ds_read_b128 v[12:15], v0 offset:10240
buffer_load_dwordx4 v6, s[8:11], s35 offen   lds
v_mfma_f32_16x16x32_bf16 v[44:47], v[164:167], v[16:19], v[44:47]
s_waitcnt lgkmcnt(2)
s_add_u32 m0, s33, 77824
v_mfma_f32_16x16x32_bf16 v[48:51], v[160:163], v[20:23], v[48:51]
ds_read_b128 v[16:19], v0 offset:12288
s_add_u32 s35, s35, 36864
v_mfma_f32_16x16x32_bf16 v[52:55], v[164:167], v[20:23], v[52:55]
s_waitcnt lgkmcnt(2)
buffer_load_dwordx4 v6, s[8:11], s35 offen   lds
v_mfma_f32_16x16x32_bf16 v[56:59], v[160:163], v[8:11], v[56:59]
ds_read_b128 v[20:23], v0 offset:14336
s_add_u32 m0, s33, 81920
v_mfma_f32_16x16x32_bf16 v[60:63], v[164:167], v[8:11], v[60:63]
s_waitcnt lgkmcnt(2)
s_add_u32 s35, s35, 36864
v_mfma_f32_16x16x32_bf16 v[64:67], v[160:163], v[12:15], v[64:67]
ds_read_b128 v[8:11], v0 offset:16384
buffer_load_dwordx4 v6, s[8:11], s35 offen   lds
v_mfma_f32_16x16x32_bf16 v[68:71], v[164:167], v[12:15], v[68:71]
s_waitcnt lgkmcnt(2)
s_add_u32 s31, s31, 128
v_mfma_f32_16x16x32_bf16 v[72:75], v[160:163], v[16:19], v[72:75]
ds_read_b128 v[12:15], v0 offset:18432
s_cmp_eq_u32 s31, 1152
s_cselect_b32 s31, 0, s31
v_mfma_f32_16x16x32_bf16 v[76:79], v[164:167], v[16:19], v[76:79]
s_waitcnt lgkmcnt(2)
v_mfma_f32_16x16x32_bf16 v[80:83], v[160:163], v[20:23], v[80:83]
ds_read_b128 v[16:19], v1 offset:0
v_mfma_f32_16x16x32_bf16 v[84:87], v[164:167], v[20:23], v[84:87]
s_waitcnt lgkmcnt(2)
v_mfma_f32_16x16x32_bf16 v[88:91], v[160:163], v[8:11], v[88:91]
ds_read_b128 v[20:23], v1 offset:2048
v_mfma_f32_16x16x32_bf16 v[92:95], v[164:167], v[8:11], v[92:95]
s_waitcnt lgkmcnt(2)
v_mfma_f32_16x16x32_bf16 v[96:99], v[160:163], v[12:15], v[96:99]
ds_read_b128 v[8:11], v1 offset:4096
v_mfma_f32_16x16x32_bf16 v[100:103], v[164:167], v[12:15], v[100:103]
s_waitcnt lgkmcnt(2)
v_mfma_f32_16x16x32_bf16 v[24:27], v[168:171], v[16:19], v[24:27]
ds_read_b128 v[12:15], v1 offset:6144
v_mfma_f32_16x16x32_bf16 v[28:31], v[172:175], v[16:19], v[28:31]
s_waitcnt lgkmcnt(2)
v_mfma_f32_16x16x32_bf16 v[32:35], v[168:171], v[20:23], v[32:35]
ds_read_b128 v[16:19], v1 offset:8192
v_mfma_f32_16x16x32_bf16 v[36:39], v[172:175], v[20:23], v[36:39]
s_waitcnt lgkmcnt(2)
v_mfma_f32_16x16x32_bf16 v[40:43], v[168:171], v[8:11], v[40:43]
ds_read_b128 v[20:23], v1 offset:10240
v_mfma_f32_16x16x32_bf16 v[44:47], v[172:175], v[8:11], v[44:47]
s_waitcnt lgkmcnt(2)
v_mfma_f32_16x16x32_bf16 v[48:51], v[168:171], v[12:15], v[48:51]
ds_read_b128 v[8:11], v1 offset:12288
v_mfma_f32_16x16x32_bf16 v[52:55], v[172:175], v[12:15], v[52:55]
s_waitcnt lgkmcnt(2)
v_mfma_f32_16x16x32_bf16 v[56:59], v[168:171], v[16:19], v[56:59]
ds_read_b128 v[12:15], v1 offset:14336
v_mfma_f32_16x16x32_bf16 v[60:63], v[172:175], v[16:19], v[60:63]
s_waitcnt lgkmcnt(2)
v_mfma_f32_16x16x32_bf16 v[64:67], v[168:171], v[20:23], v[64:67]
ds_read_b128 v[16:19], v1 offset:16384
v_mfma_f32_16x16x32_bf16 v[68:71], v[172:175], v[20:23], v[68:71]
s_waitcnt lgkmcnt(2)
v_mfma_f32_16x16x32_bf16 v[72:75], v[168:171], v[8:11], v[72:75]
s_waitcnt vmcnt(0)
s_barrier
ds_read_b128 v[20:23], v1 offset:18432
ds_read_b128 v[176:179], v4 offset:28672
v_mfma_f32_16x16x32_bf16 v[76:79], v[172:175], v[8:11], v[76:79]
s_waitcnt lgkmcnt(3)
ds_read_b128 v[180:183], v4 offset:28928
v_mfma_f32_16x16x32_bf16 v[80:83], v[168:171], v[12:15], v[80:83]
ds_read_b128 v[8:11], v0 offset:20480
ds_read_b128 v[184:187], v4 offset:36864
v_mfma_f32_16x16x32_bf16 v[84:87], v[172:175], v[12:15], v[84:87]
s_waitcnt lgkmcnt(5)
ds_read_b128 v[188:191], v4 offset:37120
v_mfma_f32_16x16x32_bf16 v[88:91], v[168:171], v[16:19], v[88:91]
ds_read_b128 v[12:15], v0 offset:22528
s_add_u32 m0, s33, 86016
v_mfma_f32_16x16x32_bf16 v[92:95], v[172:175], v[16:19], v[92:95]
s_waitcnt lgkmcnt(6)
s_add_u32 s35, s31, s32
v_mfma_f32_16x16x32_bf16 v[96:99], v[168:171], v[20:23], v[96:99]
ds_read_b128 v[16:19], v0 offset:24576
buffer_load_dwordx4 v6, s[8:11], s35 offen   lds
v_mfma_f32_16x16x32_bf16 v[100:103], v[172:175], v[20:23], v[100:103]
s_waitcnt lgkmcnt(4)
s_add_u32 m0, s33, 90112
v_mfma_f32_16x16x32_bf16 v[24:27], v[176:179], v[8:11], v[24:27]
ds_read_b128 v[20:23], v0 offset:26624
s_add_u32 s35, s35, 36864
v_mfma_f32_16x16x32_bf16 v[28:31], v[180:183], v[8:11], v[28:31]
s_waitcnt lgkmcnt(2)
buffer_load_dwordx4 v6, s[8:11], s35 offen   lds
v_mfma_f32_16x16x32_bf16 v[32:35], v[176:179], v[12:15], v[32:35]
ds_read_b128 v[8:11], v0 offset:28672
s_add_u32 m0, s33, 94208
v_mfma_f32_16x16x32_bf16 v[36:39], v[180:183], v[12:15], v[36:39]
s_waitcnt lgkmcnt(2)
s_add_u32 s35, s35, 36864
v_mfma_f32_16x16x32_bf16 v[40:43], v[176:179], v[16:19], v[40:43]
ds_read_b128 v[12:15], v0 offset:30720
buffer_load_dwordx4 v6, s[8:11], s35 offen   lds
v_mfma_f32_16x16x32_bf16 v[44:47], v[180:183], v[16:19], v[44:47]
s_waitcnt lgkmcnt(2)
s_add_u32 m0, s33, 98304
v_mfma_f32_16x16x32_bf16 v[48:51], v[176:179], v[20:23], v[48:51]
ds_read_b128 v[16:19], v0 offset:32768
s_add_u32 s35, s35, 36864
v_mfma_f32_16x16x32_bf16 v[52:55], v[180:183], v[20:23], v[52:55]
s_waitcnt lgkmcnt(2)
buffer_load_dwordx4 v6, s[8:11], s35 offen   lds
v_mfma_f32_16x16x32_bf16 v[56:59], v[176:179], v[8:11], v[56:59]
ds_read_b128 v[20:23], v0 offset:34816
s_add_u32 m0, s33, 102400
v_mfma_f32_16x16x32_bf16 v[60:63], v[180:183], v[8:11], v[60:63]
s_waitcnt lgkmcnt(2)
s_add_u32 s35, s35, 36864
v_mfma_f32_16x16x32_bf16 v[64:67], v[176:179], v[12:15], v[64:67]
ds_read_b128 v[8:11], v0 offset:36864
buffer_load_dwordx4 v6, s[8:11], s35 offen   lds
v_mfma_f32_16x16x32_bf16 v[68:71], v[180:183], v[12:15], v[68:71]
s_waitcnt lgkmcnt(2)
s_add_u32 s31, s31, 128
v_mfma_f32_16x16x32_bf16 v[72:75], v[176:179], v[16:19], v[72:75]
ds_read_b128 v[12:15], v0 offset:38912
s_cmp_eq_u32 s31, 1152
s_cselect_b32 s31, 0, s31
v_mfma_f32_16x16x32_bf16 v[76:79], v[180:183], v[16:19], v[76:79]
s_waitcnt lgkmcnt(2)
v_mfma_f32_16x16x32_bf16 v[80:83], v[176:179], v[20:23], v[80:83]
ds_read_b128 v[16:19], v1 offset:20480
v_mfma_f32_16x16x32_bf16 v[84:87], v[180:183], v[20:23], v[84:87]
s_waitcnt lgkmcnt(2)
v_mfma_f32_16x16x32_bf16 v[88:91], v[176:179], v[8:11], v[88:91]
ds_read_b128 v[20:23], v1 offset:22528
v_mfma_f32_16x16x32_bf16 v[92:95], v[180:183], v[8:11], v[92:95]
s_waitcnt lgkmcnt(2)
v_mfma_f32_16x16x32_bf16 v[96:99], v[176:179], v[12:15], v[96:99]
ds_read_b128 v[8:11], v1 offset:24576
v_mfma_f32_16x16x32_bf16 v[100:103], v[180:183], v[12:15], v[100:103]
s_waitcnt lgkmcnt(2)
v_mfma_f32_16x16x32_bf16 v[24:27], v[184:187], v[16:19], v[24:27]
ds_read_b128 v[12:15], v1 offset:26624
v_mfma_f32_16x16x32_bf16 v[28:31], v[188:191], v[16:19], v[28:31]
s_waitcnt lgkmcnt(2)
v_mfma_f32_16x16x32_bf16 v[32:35], v[184:187], v[20:23], v[32:35]
ds_read_b128 v[16:19], v1 offset:28672
v_mfma_f32_16x16x32_bf16 v[36:39], v[188:191], v[20:23], v[36:39]
s_waitcnt lgkmcnt(2)
v_mfma_f32_16x16x32_bf16 v[40:43], v[184:187], v[8:11], v[40:43]
ds_read_b128 v[20:23], v1 offset:30720
v_mfma_f32_16x16x32_bf16 v[44:47], v[188:191], v[8:11], v[44:47]
s_waitcnt lgkmcnt(2)
v_mfma_f32_16x16x32_bf16 v[48:51], v[184:187], v[12:15], v[48:51]
ds_read_b128 v[8:11], v1 offset:32768
v_mfma_f32_16x16x32_bf16 v[52:55], v[188:191], v[12:15], v[52:55]
s_waitcnt lgkmcnt(2)
v_mfma_f32_16x16x32_bf16 v[56:59], v[184:187], v[16:19], v[56:59]
ds_read_b128 v[12:15], v1 offset:34816
v_mfma_f32_16x16x32_bf16 v[60:63], v[188:191], v[16:19], v[60:63]
s_waitcnt lgkmcnt(2)
v_mfma_f32_16x16x32_bf16 v[64:67], v[184:187], v[20:23], v[64:67]
ds_read_b128 v[16:19], v1 offset:36864
v_mfma_f32_16x16x32_bf16 v[68:71], v[188:191], v[20:23], v[68:71]
s_waitcnt lgkmcnt(2)
v_mfma_f32_16x16x32_bf16 v[72:75], v[184:187], v[8:11], v[72:75]
s_waitcnt vmcnt(0)
s_barrier
ds_read_b128 v[20:23], v1 offset:38912
ds_read_b128 v[192:195], v4 offset:12288
v_mfma_f32_16x16x32_bf16 v[76:79], v[188:191], v[8:11], v[76:79]
s_waitcnt lgkmcnt(3)
ds_read_b128 v[196:199], v4 offset:12544
v_mfma_f32_16x16x32_bf16 v[80:83], v[184:187], v[12:15], v[80:83]
ds_read_b128 v[8:11], v0 offset:40960
ds_read_b128 v[200:203], v4 offset:20480
v_mfma_f32_16x16x32_bf16 v[84:87], v[188:191], v[12:15], v[84:87]
s_waitcnt lgkmcnt(5)
ds_read_b128 v[204:207], v4 offset:20736
v_mfma_f32_16x16x32_bf16 v[88:91], v[184:187], v[16:19], v[88:91]
ds_read_b128 v[12:15], v0 offset:43008
s_add_u32 m0, s33, 45056
v_mfma_f32_16x16x32_bf16 v[92:95], v[188:191], v[16:19], v[92:95]
s_waitcnt lgkmcnt(6)
s_add_u32 s35, s31, s32
v_mfma_f32_16x16x32_bf16 v[96:99], v[184:187], v[20:23], v[96:99]
ds_read_b128 v[16:19], v0 offset:45056
buffer_load_dwordx4 v6, s[8:11], s35 offen   lds
v_mfma_f32_16x16x32_bf16 v[100:103], v[188:191], v[20:23], v[100:103]
s_waitcnt lgkmcnt(4)
s_add_u32 m0, s33, 49152
v_mfma_f32_16x16x32_bf16 v[24:27], v[192:195], v[8:11], v[24:27]
ds_read_b128 v[20:23], v0 offset:47104
s_add_u32 s35, s35, 36864
v_mfma_f32_16x16x32_bf16 v[28:31], v[196:199], v[8:11], v[28:31]
s_waitcnt lgkmcnt(2)
buffer_load_dwordx4 v6, s[8:11], s35 offen   lds
v_mfma_f32_16x16x32_bf16 v[32:35], v[192:195], v[12:15], v[32:35]
ds_read_b128 v[8:11], v0 offset:49152
s_add_u32 m0, s33, 53248
v_mfma_f32_16x16x32_bf16 v[36:39], v[196:199], v[12:15], v[36:39]
s_waitcnt lgkmcnt(2)
s_add_u32 s35, s35, 36864
v_mfma_f32_16x16x32_bf16 v[40:43], v[192:195], v[16:19], v[40:43]
ds_read_b128 v[12:15], v0 offset:51200
buffer_load_dwordx4 v6, s[8:11], s35 offen   lds
v_mfma_f32_16x16x32_bf16 v[44:47], v[196:199], v[16:19], v[44:47]
s_waitcnt lgkmcnt(2)
s_add_u32 m0, s33, 57344
v_mfma_f32_16x16x32_bf16 v[48:51], v[192:195], v[20:23], v[48:51]
ds_read_b128 v[16:19], v0 offset:53248
s_add_u32 s35, s35, 36864
v_mfma_f32_16x16x32_bf16 v[52:55], v[196:199], v[20:23], v[52:55]
s_waitcnt lgkmcnt(2)
buffer_load_dwordx4 v6, s[8:11], s35 offen   lds
v_mfma_f32_16x16x32_bf16 v[56:59], v[192:195], v[8:11], v[56:59]
ds_read_b128 v[20:23], v0 offset:55296
s_add_u32 m0, s33, 61440
v_mfma_f32_16x16x32_bf16 v[60:63], v[196:199], v[8:11], v[60:63]
s_waitcnt lgkmcnt(2)
s_add_u32 s35, s35, 36864
v_mfma_f32_16x16x32_bf16 v[64:67], v[192:195], v[12:15], v[64:67]
ds_read_b128 v[8:11], v0 offset:57344
buffer_load_dwordx4 v6, s[8:11], s35 offen   lds
v_mfma_f32_16x16x32_bf16 v[68:71], v[196:199], v[12:15], v[68:71]
s_waitcnt lgkmcnt(2)
s_add_u32 s31, s31, 128
v_mfma_f32_16x16x32_bf16 v[72:75], v[192:195], v[16:19], v[72:75]
ds_read_b128 v[12:15], v0 offset:59392
s_cmp_eq_u32 s31, 1152
s_cselect_b32 s31, 0, s31
v_mfma_f32_16x16x32_bf16 v[76:79], v[196:199], v[16:19], v[76:79]
s_waitcnt lgkmcnt(2)
v_mfma_f32_16x16x32_bf16 v[80:83], v[192:195], v[20:23], v[80:83]
ds_read_b128 v[16:19], v1 offset:40960
v_mfma_f32_16x16x32_bf16 v[84:87], v[196:199], v[20:23], v[84:87]
s_waitcnt lgkmcnt(2)
v_mfma_f32_16x16x32_bf16 v[88:91], v[192:195], v[8:11], v[88:91]
ds_read_b128 v[20:23], v1 offset:43008
v_mfma_f32_16x16x32_bf16 v[92:95], v[196:199], v[8:11], v[92:95]
s_waitcnt lgkmcnt(2)
v_mfma_f32_16x16x32_bf16 v[96:99], v[192:195], v[12:15], v[96:99]
ds_read_b128 v[8:11], v1 offset:45056
v_mfma_f32_16x16x32_bf16 v[100:103], v[196:199], v[12:15], v[100:103]
s_waitcnt lgkmcnt(2)
v_mfma_f32_16x16x32_bf16 v[24:27], v[200:203], v[16:19], v[24:27]
ds_read_b128 v[12:15], v1 offset:47104
v_mfma_f32_16x16x32_bf16 v[28:31], v[204:207], v[16:19], v[28:31]
s_waitcnt lgkmcnt(2)
v_mfma_f32_16x16x32_bf16 v[32:35], v[200:203], v[20:23], v[32:35]
ds_read_b128 v[16:19], v1 offset:49152
v_mfma_f32_16x16x32_bf16 v[36:39], v[204:207], v[20:23], v[36:39]
s_waitcnt lgkmcnt(2)
v_mfma_f32_16x16x32_bf16 v[40:43], v[200:203], v[8:11], v[40:43]
ds_read_b128 v[20:23], v1 offset:51200
L_pad2:
s_cmp_eq_u32 s57, 1
s_cbranch_scc1 L_wret
v_mfma_f32_16x16x32_bf16 v[44:47], v[204:207], v[8:11], v[44:47]
s_waitcnt lgkmcnt(2)
v_mfma_f32_16x16x32_bf16 v[48:51], v[200:203], v[12:15], v[48:51]
ds_read_b128 v[8:11], v1 offset:53248
v_mfma_f32_16x16x32_bf16 v[52:55], v[204:207], v[12:15], v[52:55]
s_waitcnt lgkmcnt(2)
v_mfma_f32_16x16x32_bf16 v[56:59], v[200:203], v[16:19], v[56:59]
ds_read_b128 v[12:15], v1 offset:55296
v_mfma_f32_16x16x32_bf16 v[60:63], v[204:207], v[16:19], v[60:63]
s_waitcnt lgkmcnt(2)
v_mfma_f32_16x16x32_bf16 v[64:67], v[200:203], v[20:23], v[64:67]
ds_read_b128 v[16:19], v1 offset:57344
v_mfma_f32_16x16x32_bf16 v[68:71], v[204:207], v[20:23], v[68:71]
s_waitcnt lgkmcnt(2)
v_mfma_f32_16x16x32_bf16 v[72:75], v[200:203], v[8:11], v[72:75]
s_waitcnt vmcnt(0)
s_barrier
ds_read_b128 v[20:23], v1 offset:59392
ds_read_b128 v[208:211], v4 offset:28672
v_mfma_f32_16x16x32_bf16 v[76:79], v[204:207], v[8:11], v[76:79]
s_waitcnt lgkmcnt(3)
ds_read_b128 v[212:215], v4 offset:28928
v_mfma_f32_16x16x32_bf16 v[80:83], v[200:203], v[12:15], v[80:83]
ds_read_b128 v[8:11], v0 offset:0
ds_read_b128 v[216:219], v4 offset:36864
v_mfma_f32_16x16x32_bf16 v[84:87], v[204:207], v[12:15], v[84:87]
s_waitcnt lgkmcnt(5)
ds_read_b128 v[220:223], v4 offset:37120
v_mfma_f32_16x16x32_bf16 v[88:91], v[200:203], v[16:19], v[88:91]
ds_read_b128 v[12:15], v0 offset:2048
s_add_u32 m0, s33, 65536
v_mfma_f32_16x16x32_bf16 v[92:95], v[204:207], v[16:19], v[92:95]
s_waitcnt lgkmcnt(6)
s_add_u32 s35, s31, s32
v_mfma_f32_16x16x32_bf16 v[96:99], v[200:203], v[20:23], v[96:99]
ds_read_b128 v[16:19], v0 offset:4096
buffer_load_dwordx4 v6, s[8:11], s35 offen   lds
v_mfma_f32_16x16x32_bf16 v[100:103], v[204:207], v[20:23], v[100:103]
s_waitcnt lgkmcnt(4)
s_add_u32 m0, s33, 69632
v_mfma_f32_16x16x32_bf16 v[24:27], v[208:211], v[8:11], v[24:27]
ds_read_b128 v[20:23], v0 offset:6144
s_add_u32 s35, s35, 36864
v_mfma_f32_16x16x32_bf16 v[28:31], v[212:215], v[8:11], v[28:31]
s_waitcnt lgkmcnt(2)
buffer_load_dwordx4 v6, s[8:11], s35 offen   lds
v_mfma_f32_16x16x32_bf16 v[32:35], v[208:211], v[12:15], v[32:35]
ds_read_b128 v[8:11], v0 offset:8192
s_add_u32 m0, s33, 73728
v_mfma_f32_16x16x32_bf16 v[36:39], v[212:215], v[12:15], v[36:39]
s_waitcnt lgkmcnt(2)
s_add_u32 s35, s35, 36864
v_mfma_f32_16x16x32_bf16 v[40:43], v[208:211], v[16:19], v[40:43]
ds_read_b128 v[12:15], v0 offset:10240
buffer_load_dwordx4 v6, s[8:11], s35 offen   lds
v_mfma_f32_16x16x32_bf16 v[44:47], v[212:215], v[16:19], v[44:47]
s_waitcnt lgkmcnt(2)
s_add_u32 m0, s33, 77824
v_mfma_f32_16x16x32_bf16 v[48:51], v[208:211], v[20:23], v[48:51]
ds_read_b128 v[16:19], v0 offset:12288
s_add_u32 s35, s35, 36864
v_mfma_f32_16x16x32_bf16 v[52:55], v[212:215], v[20:23], v[52:55]
s_waitcnt lgkmcnt(2)
buffer_load_dwordx4 v6, s[8:11], s35 offen   lds
v_mfma_f32_16x16x32_bf16 v[56:59], v[208:211], v[8:11], v[56:59]
ds_read_b128 v[20:23], v0 offset:14336
s_add_u32 m0, s33, 81920
v_mfma_f32_16x16x32_bf16 v[60:63], v[212:215], v[8:11], v[60:63]
s_waitcnt lgkmcnt(2)
s_add_u32 s35, s35, 36864
v_mfma_f32_16x16x32_bf16 v[64:67], v[208:211], v[12:15], v[64:67]
ds_read_b128 v[8:11], v0 offset:16384
buffer_load_dwordx4 v6, s[8:11], s35 offen   lds
v_mfma_f32_16x16x32_bf16 v[68:71], v[212:215], v[12:15], v[68:71]
s_waitcnt lgkmcnt(2)
s_add_u32 s31, s31, 128
v_mfma_f32_16x16x32_bf16 v[72:75], v[208:211], v[16:19], v[72:75]
ds_read_b128 v[12:15], v0 offset:18432
s_cmp_eq_u32 s31, 1152
s_cselect_b32 s31, 0, s31
v_mfma_f32_16x16x32_bf16 v[76:79], v[212:215], v[16:19], v[76:79]
s_waitcnt lgkmcnt(2)
v_mfma_f32_16x16x32_bf16 v[80:83], v[208:211], v[20:23], v[80:83]
ds_read_b128 v[16:19], v1 offset:0
v_mfma_f32_16x16x32_bf16 v[84:87], v[212:215], v[20:23], v[84:87]
s_waitcnt lgkmcnt(2)
v_mfma_f32_16x16x32_bf16 v[88:91], v[208:211], v[8:11], v[88:91]
ds_read_b128 v[20:23], v1 offset:2048
v_mfma_f32_16x16x32_bf16 v[92:95], v[212:215], v[8:11], v[92:95]
s_waitcnt lgkmcnt(2)
v_mfma_f32_16x16x32_bf16 v[96:99], v[208:211], v[12:15], v[96:99]
ds_read_b128 v[8:11], v1 offset:4096
v_mfma_f32_16x16x32_bf16 v[100:103], v[212:215], v[12:15], v[100:103]
s_waitcnt lgkmcnt(2)
v_mfma_f32_16x16x32_bf16 v[24:27], v[216:219], v[16:19], v[24:27]
ds_read_b128 v[12:15], v1 offset:6144
v_mfma_f32_16x16x32_bf16 v[28:31], v[220:223], v[16:19], v[28:31]
s_waitcnt lgkmcnt(2)
v_mfma_f32_16x16x32_bf16 v[32:35], v[216:219], v[20:23], v[32:35]
ds_read_b128 v[16:19], v1 offset:8192
v_mfma_f32_16x16x32_bf16 v[36:39], v[220:223], v[20:23], v[36:39]
s_waitcnt lgkmcnt(2)
v_mfma_f32_16x16x32_bf16 v[40:43], v[216:219], v[8:11], v[40:43]
ds_read_b128 v[20:23], v1 offset:10240
v_mfma_f32_16x16x32_bf16 v[44:47], v[220:223], v[8:11], v[44:47]
s_waitcnt lgkmcnt(2)
v_mfma_f32_16x16x32_bf16 v[48:51], v[216:219], v[12:15], v[48:51]
ds_read_b128 v[8:11], v1 offset:12288
v_mfma_f32_16x16x32_bf16 v[52:55], v[220:223], v[12:15], v[52:55]
s_waitcnt lgkmcnt(2)
v_mfma_f32_16x16x32_bf16 v[56:59], v[216:219], v[16:19], v[56:59]
ds_read_b128 v[12:15], v1 offset:14336
v_mfma_f32_16x16x32_bf16 v[60:63], v[220:223], v[16:19], v[60:63]
s_waitcnt lgkmcnt(2)
v_mfma_f32_16x16x32_bf16 v[64:67], v[216:219], v[20:23], v[64:67]
ds_read_b128 v[16:19], v1 offset:16384
v_mfma_f32_16x16x32_bf16 v[68:71], v[220:223], v[20:23], v[68:71]
s_waitcnt lgkmcnt(2)
v_mfma_f32_16x16x32_bf16 v[72:75], v[216:219], v[8:11], v[72:75]
s_waitcnt vmcnt(0)
s_barrier
ds_read_b128 v[20:23], v1 offset:18432
ds_read_b128 v[224:227], v4 offset:12288
v_mfma_f32_16x16x32_bf16 v[76:79], v[220:223], v[8:11], v[76:79]
s_waitcnt lgkmcnt(3)
ds_read_b128 v[228:231], v4 offset:12544
v_mfma_f32_16x16x32_bf16 v[80:83], v[216:219], v[12:15], v[80:83]
ds_read_b128 v[8:11], v0 offset:20480
ds_read_b128 v[232:235], v4 offset:20480
v_mfma_f32_16x16x32_bf16 v[84:87], v[220:223], v[12:15], v[84:87]
s_waitcnt lgkmcnt(5)
ds_read_b128 v[236:239], v4 offset:20736
v_mfma_f32_16x16x32_bf16 v[88:91], v[216:219], v[16:19], v[88:91]
ds_read_b128 v[12:15], v0 offset:22528
s_add_u32 m0, s33, 86016
v_mfma_f32_16x16x32_bf16 v[92:95], v[220:223], v[16:19], v[92:95]
s_waitcnt lgkmcnt(6)
s_add_u32 s35, s31, s32
v_mfma_f32_16x16x32_bf16 v[96:99], v[216:219], v[20:23], v[96:99]
ds_read_b128 v[16:19], v0 offset:24576
buffer_load_dwordx4 v6, s[8:11], s35 offen   lds
v_mfma_f32_16x16x32_bf16 v[100:103], v[220:223], v[20:23], v[100:103]
s_waitcnt lgkmcnt(4)
s_add_u32 m0, s33, 90112
v_mfma_f32_16x16x32_bf16 v[24:27], v[224:227], v[8:11], v[24:27]
ds_read_b128 v[20:23], v0 offset:26624
s_add_u32 s35, s35, 36864
v_mfma_f32_16x16x32_bf16 v[28:31], v[228:231], v[8:11], v[28:31]
s_waitcnt lgkmcnt(2)
buffer_load_dwordx4 v6, s[8:11], s35 offen   lds
v_mfma_f32_16x16x32_bf16 v[32:35], v[224:227], v[12:15], v[32:35]
ds_read_b128 v[8:11], v0 offset:28672
s_add_u32 m0, s33, 94208
v_mfma_f32_16x16x32_bf16 v[36:39], v[228:231], v[12:15], v[36:39]
s_waitcnt lgkmcnt(2)
s_add_u32 s35, s35, 36864
v_mfma_f32_16x16x32_bf16 v[40:43], v[224:227], v[16:19], v[40:43]
ds_read_b128 v[12:15], v0 offset:30720
buffer_load_dwordx4 v6, s[8:11], s35 offen   lds
v_mfma_f32_16x16x32_bf16 v[44:47], v[228:231], v[16:19], v[44:47]
s_waitcnt lgkmcnt(2)
s_add_u32 m0, s33, 98304
v_mfma_f32_16x16x32_bf16 v[48:51], v[224:227], v[20:23], v[48:51]
ds_read_b128 v[16:19], v0 offset:32768
s_add_u32 s35, s35, 36864
v_mfma_f32_16x16x32_bf16 v[52:55], v[228:231], v[20:23], v[52:55]
s_waitcnt lgkmcnt(2)
buffer_load_dwordx4 v6, s[8:11], s35 offen   lds
v_mfma_f32_16x16x32_bf16 v[56:59], v[224:227], v[8:11], v[56:59]
ds_read_b128 v[20:23], v0 offset:34816
s_add_u32 m0, s33, 102400
v_mfma_f32_16x16x32_bf16 v[60:63], v[228:231], v[8:11], v[60:63]
s_waitcnt lgkmcnt(2)
s_add_u32 s35, s35, 36864
v_mfma_f32_16x16x32_bf16 v[64:67], v[224:227], v[12:15], v[64:67]
ds_read_b128 v[8:11], v0 offset:36864
buffer_load_dwordx4 v6, s[8:11], s35 offen   lds
v_mfma_f32_16x16x32_bf16 v[68:71], v[228:231], v[12:15], v[68:71]
s_waitcnt lgkmcnt(2)
v_mfma_f32_16x16x32_bf16 v[72:75], v[224:227], v[16:19], v[72:75]
ds_read_b128 v[12:15], v0 offset:38912
v_mfma_f32_16x16x32_bf16 v[76:79], v[228:231], v[16:19], v[76:79]
s_waitcnt lgkmcnt(2)
v_mfma_f32_16x16x32_bf16 v[80:83], v[224:227], v[20:23], v[80:83]
ds_read_b128 v[16:19], v1 offset:20480
v_mfma_f32_16x16x32_bf16 v[84:87], v[228:231], v[20:23], v[84:87]
s_waitcnt lgkmcnt(2)
v_mfma_f32_16x16x32_bf16 v[88:91], v[224:227], v[8:11], v[88:91]
ds_read_b128 v[20:23], v1 offset:22528
v_mfma_f32_16x16x32_bf16 v[92:95], v[228:231], v[8:11], v[92:95]
s_waitcnt lgkmcnt(2)
v_mfma_f32_16x16x32_bf16 v[96:99], v[224:227], v[12:15], v[96:99]
ds_read_b128 v[8:11], v1 offset:24576
v_mfma_f32_16x16x32_bf16 v[100:103], v[228:231], v[12:15], v[100:103]
s_waitcnt lgkmcnt(2)
v_mfma_f32_16x16x32_bf16 v[24:27], v[232:235], v[16:19], v[24:27]
ds_read_b128 v[12:15], v1 offset:26624
v_mfma_f32_16x16x32_bf16 v[28:31], v[236:239], v[16:19], v[28:31]
s_waitcnt lgkmcnt(2)
v_mfma_f32_16x16x32_bf16 v[32:35], v[232:235], v[20:23], v[32:35]
ds_read_b128 v[16:19], v1 offset:28672
v_mfma_f32_16x16x32_bf16 v[36:39], v[236:239], v[20:23], v[36:39]
s_waitcnt lgkmcnt(2)
v_mfma_f32_16x16x32_bf16 v[40:43], v[232:235], v[8:11], v[40:43]
ds_read_b128 v[20:23], v1 offset:30720
v_mfma_f32_16x16x32_bf16 v[44:47], v[236:239], v[8:11], v[44:47]
s_waitcnt lgkmcnt(2)
v_mfma_f32_16x16x32_bf16 v[48:51], v[232:235], v[12:15], v[48:51]
ds_read_b128 v[8:11], v1 offset:32768
v_mfma_f32_16x16x32_bf16 v[52:55], v[236:239], v[12:15], v[52:55]
s_waitcnt lgkmcnt(2)
v_mfma_f32_16x16x32_bf16 v[56:59], v[232:235], v[16:19], v[56:59]
ds_read_b128 v[12:15], v1 offset:34816
v_mfma_f32_16x16x32_bf16 v[60:63], v[236:239], v[16:19], v[60:63]
s_waitcnt lgkmcnt(2)
v_mfma_f32_16x16x32_bf16 v[64:67], v[232:235], v[20:23], v[64:67]
ds_read_b128 v[16:19], v1 offset:36864
v_mfma_f32_16x16x32_bf16 v[68:71], v[236:239], v[20:23], v[68:71]
s_waitcnt lgkmcnt(2)
v_mfma_f32_16x16x32_bf16 v[72:75], v[232:235], v[8:11], v[72:75]
s_waitcnt vmcnt(0)
s_barrier
ds_read_b128 v[20:23], v1 offset:38912
ds_read_b128 v[240:243], v4 offset:28672
v_mfma_f32_16x16x32_bf16 v[76:79], v[236:239], v[8:11], v[76:79]
s_waitcnt lgkmcnt(3)
ds_read_b128 v[244:247], v4 offset:28928
v_mfma_f32_16x16x32_bf16 v[80:83], v[232:235], v[12:15], v[80:83]
ds_read_b128 v[8:11], v0 offset:40960
ds_read_b128 v[248:251], v4 offset:36864
v_mfma_f32_16x16x32_bf16 v[84:87], v[236:239], v[12:15], v[84:87]
s_waitcnt lgkmcnt(5)
ds_read_b128 v[252:255], v4 offset:37120
v_mfma_f32_16x16x32_bf16 v[88:91], v[232:235], v[16:19], v[88:91]
ds_read_b128 v[12:15], v1 offset:40960
v_mfma_f32_16x16x32_bf16 v[92:95], v[236:239], v[16:19], v[92:95]
s_waitcnt lgkmcnt(6)
v_mfma_f32_16x16x32_bf16 v[96:99], v[232:235], v[20:23], v[96:99]
ds_read_b128 v[16:19], v0 offset:43008
v_mfma_f32_16x16x32_bf16 v[100:103], v[236:239], v[20:23], v[100:103]
s_waitcnt lgkmcnt(4)
v_mfma_f32_16x16x32_bf16 v[24:27], v[240:243], v[8:11], v[24:27]
ds_read_b128 v[20:23], v1 offset:43008
v_mfma_f32_16x16x32_bf16 v[28:31], v[244:247], v[8:11], v[28:31]
s_waitcnt lgkmcnt(2)
v_mfma_f32_16x16x32_bf16 v[24:27], v[248:251], v[12:15], v[24:27]
ds_read_b128 v[8:11], v0 offset:45056
v_mfma_f32_16x16x32_bf16 v[28:31], v[252:255], v[12:15], v[28:31]
s_waitcnt lgkmcnt(2)
v_mfma_f32_16x16x32_bf16 v[32:35], v[240:243], v[16:19], v[32:35]
ds_read_b128 v[12:15], v1 offset:45056
v_mfma_f32_16x16x32_bf16 v[36:39], v[244:247], v[16:19], v[36:39]
s_waitcnt lgkmcnt(2)
v_mfma_f32_16x16x32_bf16 v[32:35], v[248:251], v[20:23], v[32:35]
ds_read_b128 v[16:19], v0 offset:47104
v_mfma_f32_16x16x32_bf16 v[36:39], v[252:255], v[20:23], v[36:39]
s_waitcnt lgkmcnt(2)
v_mfma_f32_16x16x32_bf16 v[40:43], v[240:243], v[8:11], v[40:43]
ds_read_b128 v[20:23], v1 offset:47104
v_cvt_pk_bf16_f32 v24, v24, v28
v_mfma_f32_16x16x32_bf16 v[44:47], v[244:247], v[8:11], v[44:47]
s_waitcnt lgkmcnt(2)
v_cvt_pk_bf16_f32 v25, v25, v29
v_mfma_f32_16x16x32_bf16 v[40:43], v[248:251], v[12:15], v[40:43]
ds_read_b128 v[8:11], v0 offset:49152
v_cvt_pk_bf16_f32 v26, v26, v30
v_mfma_f32_16x16x32_bf16 v[44:47], v[252:255], v[12:15], v[44:47]
s_waitcnt lgkmcnt(2)
ds_write_b64 v5, v[24:25] offset:0
v_mfma_f32_16x16x32_bf16 v[48:51], v[240:243], v[16:19], v[48:51]
ds_read_b128 v[12:15], v1 offset:49152
v_cvt_pk_bf16_f32 v27, v27, v31
v_mfma_f32_16x16x32_bf16 v[52:55], v[244:247], v[16:19], v[52:55]
s_waitcnt lgkmcnt(3)
ds_write_b64 v5, v[26:27] offset:2048
v_mfma_f32_16x16x32_bf16 v[48:51], v[248:251], v[20:23], v[48:51]
ds_read_b128 v[16:19], v0 offset:51200
v_cvt_pk_bf16_f32 v32, v32, v36
v_mfma_f32_16x16x32_bf16 v[52:55], v[252:255], v[20:23], v[52:55]
s_waitcnt lgkmcnt(4)
v_cvt_pk_bf16_f32 v33, v33, v37
v_mfma_f32_16x16x32_bf16 v[56:59], v[240:243], v[8:11], v[56:59]
ds_read_b128 v[20:23], v1 offset:51200
v_cvt_pk_bf16_f32 v34, v34, v38
v_mfma_f32_16x16x32_bf16 v[60:63], v[244:247], v[8:11], v[60:63]
s_waitcnt lgkmcnt(3)
ds_write_b64 v5, v[32:33] offset:4096
v_mfma_f32_16x16x32_bf16 v[56:59], v[248:251], v[12:15], v[56:59]
ds_read_b128 v[8:11], v0 offset:53248
v_cvt_pk_bf16_f32 v35, v35, v39
v_mfma_f32_16x16x32_bf16 v[60:63], v[252:255], v[12:15], v[60:63]
s_waitcnt lgkmcnt(3)
ds_write_b64 v5, v[34:35] offset:6144
v_mfma_f32_16x16x32_bf16 v[64:67], v[240:243], v[16:19], v[64:67]
ds_read_b128 v[12:15], v1 offset:53248
v_mfma_f32_16x16x32_bf16 v[68:71], v[244:247], v[16:19], v[68:71]
s_waitcnt lgkmcnt(4)
v_mfma_f32_16x16x32_bf16 v[64:67], v[248:251], v[20:23], v[64:67]
ds_read_b128 v[16:19], v0 offset:55296
v_mfma_f32_16x16x32_bf16 v[68:71], v[252:255], v[20:23], v[68:71]
s_waitcnt lgkmcnt(3)
v_mfma_f32_16x16x32_bf16 v[72:75], v[240:243], v[8:11], v[72:75]
ds_read_b128 v[20:23], v1 offset:55296
v_mfma_f32_16x16x32_bf16 v[76:79], v[244:247], v[8:11], v[76:79]
s_waitcnt lgkmcnt(2)
v_mfma_f32_16x16x32_bf16 v[72:75], v[248:251], v[12:15], v[72:75]
ds_read_b128 v[8:11], v0 offset:57344
v_mfma_f32_16x16x32_bf16 v[76:79], v[252:255], v[12:15], v[76:79]
s_waitcnt lgkmcnt(2)
v_mfma_f32_16x16x32_bf16 v[80:83], v[240:243], v[16:19], v[80:83]
ds_read_b128 v[12:15], v1 offset:57344
v_mfma_f32_16x16x32_bf16 v[84:87], v[244:247], v[16:19], v[84:87]
s_waitcnt lgkmcnt(2)
v_mfma_f32_16x16x32_bf16 v[80:83], v[248:251], v[20:23], v[80:83]
ds_read_b128 v[16:19], v0 offset:59392
v_mfma_f32_16x16x32_bf16 v[84:87], v[252:255], v[20:23], v[84:87]
s_waitcnt lgkmcnt(2)
v_mfma_f32_16x16x32_bf16 v[88:91], v[240:243], v[8:11], v[88:91]
ds_read_b128 v[20:23], v1 offset:59392
v_mfma_f32_16x16x32_bf16 v[92:95], v[244:247], v[8:11], v[92:95]
s_waitcnt lgkmcnt(2)
v_mfma_f32_16x16x32_bf16 v[88:91], v[248:251], v[12:15], v[88:91]
s_barrier
ds_read_b128 v[8:11], v0 offset:61440
v_mfma_f32_16x16x32_bf16 v[92:95], v[252:255], v[12:15], v[92:95]
s_waitcnt lgkmcnt(2)
v_mfma_f32_16x16x32_bf16 v[96:99], v[240:243], v[16:19], v[96:99]
ds_read_b128 v[12:15], v1 offset:61440
v_mfma_f32_16x16x32_bf16 v[100:103], v[244:247], v[16:19], v[100:103]
s_waitcnt lgkmcnt(2)
v_mfma_f32_16x16x32_bf16 v[96:99], v[248:251], v[20:23], v[96:99]
ds_read_b128 v[16:19], v0 offset:63488
v_mfma_f32_16x16x32_bf16 v[100:103], v[252:255], v[20:23], v[100:103]
s_waitcnt lgkmcnt(2)
v_mfma_f32_16x16x32_bf16 v[24:27], v[112:115], v[8:11], 0
ds_read_b128 v[20:23], v1 offset:63488
v_cvt_pk_bf16_f32 v40, v40, v44
v_mfma_f32_16x16x32_bf16 v[28:31], v[116:119], v[8:11], 0
s_waitcnt lgkmcnt(2)
v_cvt_pk_bf16_f32 v41, v41, v45
v_mfma_f32_16x16x32_bf16 v[24:27], v[120:123], v[12:15], v[24:27]
ds_read_b128 v[8:11], v2 offset:7168
v_cvt_pk_bf16_f32 v42, v42, v46
v_mfma_f32_16x16x32_bf16 v[28:31], v[124:127], v[12:15], v[28:31]
s_waitcnt lgkmcnt(2)
ds_write_b64 v5, v[40:41] offset:8192
v_mfma_f32_16x16x32_bf16 v[24:27], v[128:131], v[16:19], v[24:27]
ds_read_b128 v[12:15], v3 offset:7168
v_cvt_pk_bf16_f32 v43, v43, v47
v_mfma_f32_16x16x32_bf16 v[28:31], v[132:135], v[16:19], v[28:31]
s_waitcnt lgkmcnt(3)
ds_write_b64 v5, v[42:43] offset:10240
v_mfma_f32_16x16x32_bf16 v[24:27], v[136:139], v[20:23], v[24:27]
ds_read_b128 v[16:19], v2 offset:9216
v_mfma_f32_16x16x32_bf16 v[28:31], v[140:143], v[20:23], v[28:31]
s_waitcnt lgkmcnt(4)
v_mfma_f32_16x16x32_bf16 v[24:27], v[144:147], v[8:11], v[24:27]
ds_read_b128 v[20:23], v3 offset:9216
v_mfma_f32_16x16x32_bf16 v[28:31], v[148:151], v[8:11], v[28:31]
s_waitcnt lgkmcnt(3)
v_mfma_f32_16x16x32_bf16 v[24:27], v[152:155], v[12:15], v[24:27]
ds_read_b128 v[8:11], v2 offset:11264
v_mfma_f32_16x16x32_bf16 v[28:31], v[156:159], v[12:15], v[28:31]
s_waitcnt lgkmcnt(2)
v_mfma_f32_16x16x32_bf16 v[24:27], v[160:163], v[16:19], v[24:27]
ds_read_b128 v[12:15], v3 offset:11264
v_mfma_f32_16x16x32_bf16 v[28:31], v[164:167], v[16:19], v[28:31]
s_waitcnt lgkmcnt(2)
v_mfma_f32_16x16x32_bf16 v[24:27], v[168:171], v[20:23], v[24:27]
ds_read_b128 v[16:19], v2 offset:13312
v_mfma_f32_16x16x32_bf16 v[28:31], v[172:175], v[20:23], v[28:31]
s_waitcnt lgkmcnt(2)
v_mfma_f32_16x16x32_bf16 v[24:27], v[176:179], v[8:11], v[24:27]
ds_read_b128 v[20:23], v3 offset:13312
v_mfma_f32_16x16x32_bf16 v[28:31], v[180:183], v[8:11], v[28:31]
s_waitcnt lgkmcnt(2)
v_mfma_f32_16x16x32_bf16 v[24:27], v[184:187], v[12:15], v[24:27]
ds_read_b128 v[8:11], v2 offset:15360
v_mfma_f32_16x16x32_bf16 v[28:31], v[188:191], v[12:15], v[28:31]
s_waitcnt lgkmcnt(2)
v_mfma_f32_16x16x32_bf16 v[24:27], v[192:195], v[16:19], v[24:27]
ds_read_b128 v[12:15], v3 offset:15360
v_mfma_f32_16x16x32_bf16 v[28:31], v[196:199], v[16:19], v[28:31]
s_waitcnt lgkmcnt(2)
v_mfma_f32_16x16x32_bf16 v[24:27], v[200:203], v[20:23], v[24:27]
ds_read_b128 v[16:19], v2 offset:17408
v_mfma_f32_16x16x32_bf16 v[28:31], v[204:207], v[20:23], v[28:31]
s_waitcnt lgkmcnt(2)
v_mfma_f32_16x16x32_bf16 v[24:27], v[208:211], v[8:11], v[24:27]
ds_read_b128 v[20:23], v3 offset:17408
v_mfma_f32_16x16x32_bf16 v[28:31], v[212:215], v[8:11], v[28:31]
s_waitcnt lgkmcnt(2)
v_mfma_f32_16x16x32_bf16 v[24:27], v[216:219], v[12:15], v[24:27]
ds_read_b128 v[8:11], v2 offset:19456
v_mfma_f32_16x16x32_bf16 v[28:31], v[220:223], v[12:15], v[28:31]
s_waitcnt lgkmcnt(2)
v_mfma_f32_16x16x32_bf16 v[24:27], v[224:227], v[16:19], v[24:27]
ds_read_b128 v[12:15], v3 offset:19456
v_mfma_f32_16x16x32_bf16 v[28:31], v[228:231], v[16:19], v[28:31]
s_waitcnt lgkmcnt(2)
v_mfma_f32_16x16x32_bf16 v[24:27], v[232:235], v[20:23], v[24:27]
s_barrier
ds_read_b128 v[16:19], v2 offset:21504
v_mfma_f32_16x16x32_bf16 v[28:31], v[236:239], v[20:23], v[28:31]
s_waitcnt lgkmcnt(2)
v_mfma_f32_16x16x32_bf16 v[24:27], v[240:243], v[8:11], v[24:27]
ds_read_b128 v[20:23], v3 offset:21504
v_mfma_f32_16x16x32_bf16 v[28:31], v[244:247], v[8:11], v[28:31]
s_waitcnt lgkmcnt(2)
v_mfma_f32_16x16x32_bf16 v[24:27], v[248:251], v[12:15], v[24:27]
ds_read_b128 v[8:11], v2 offset:23552
v_mfma_f32_16x16x32_bf16 v[28:31], v[252:255], v[12:15], v[28:31]
s_waitcnt lgkmcnt(2)
v_mfma_f32_16x16x32_bf16 v[32:35], v[112:115], v[16:19], 0
ds_read_b128 v[12:15], v3 offset:23552
v_mfma_f32_16x16x32_bf16 v[36:39], v[116:119], v[16:19], 0
s_waitcnt lgkmcnt(2)
v_mfma_f32_16x16x32_bf16 v[32:35], v[120:123], v[20:23], v[32:35]
ds_read_b128 v[16:19], v2 offset:25600
v_mfma_f32_16x16x32_bf16 v[36:39], v[124:127], v[20:23], v[36:39]
s_waitcnt lgkmcnt(2)
v_mfma_f32_16x16x32_bf16 v[32:35], v[128:131], v[8:11], v[32:35]
ds_read_b128 v[20:23], v3 offset:25600
v_cvt_pk_bf16_f32 v24, v24, v28
v_mfma_f32_16x16x32_bf16 v[36:39], v[132:135], v[8:11], v[36:39]
s_waitcnt lgkmcnt(2)
v_cvt_pk_bf16_f32 v25, v25, v29
v_mfma_f32_16x16x32_bf16 v[32:35], v[136:139], v[12:15], v[32:35]
ds_read_b128 v[8:11], v2 offset:27648
v_cvt_pk_bf16_f32 v26, v26, v30
v_mfma_f32_16x16x32_bf16 v[36:39], v[140:143], v[12:15], v[36:39]
s_waitcnt lgkmcnt(2)
ds_write_b64 v5, v[24:25] offset:12288
v_mfma_f32_16x16x32_bf16 v[32:35], v[144:147], v[16:19], v[32:35]
ds_read_b128 v[12:15], v3 offset:27648
v_cvt_pk_bf16_f32 v27, v27, v31
v_mfma_f32_16x16x32_bf16 v[36:39], v[148:151], v[16:19], v[36:39]
s_waitcnt lgkmcnt(3)
ds_write_b64 v5, v[26:27] offset:14336
v_mfma_f32_16x16x32_bf16 v[32:35], v[152:155], v[20:23], v[32:35]
ds_read_b128 v[16:19], v2 offset:29696
v_mfma_f32_16x16x32_bf16 v[36:39], v[156:159], v[20:23], v[36:39]
s_waitcnt lgkmcnt(4)
v_mfma_f32_16x16x32_bf16 v[32:35], v[160:163], v[8:11], v[32:35]
ds_read_b128 v[20:23], v3 offset:29696
v_mfma_f32_16x16x32_bf16 v[36:39], v[164:167], v[8:11], v[36:39]
s_waitcnt lgkmcnt(3)
v_mfma_f32_16x16x32_bf16 v[32:35], v[168:171], v[12:15], v[32:35]
ds_read_b128 v[8:11], v2 offset:31744
v_mfma_f32_16x16x32_bf16 v[36:39], v[172:175], v[12:15], v[36:39]
s_waitcnt lgkmcnt(2)
v_mfma_f32_16x16x32_bf16 v[32:35], v[176:179], v[16:19], v[32:35]
ds_read_b128 v[12:15], v3 offset:31744
v_mfma_f32_16x16x32_bf16 v[36:39], v[180:183], v[16:19], v[36:39]
s_waitcnt lgkmcnt(2)
v_mfma_f32_16x16x32_bf16 v[32:35], v[184:187], v[20:23], v[32:35]
ds_read_b128 v[16:19], v2 offset:33792
v_mfma_f32_16x16x32_bf16 v[36:39], v[188:191], v[20:23], v[36:39]
s_waitcnt lgkmcnt(2)
v_mfma_f32_16x16x32_bf16 v[32:35], v[192:195], v[8:11], v[32:35]
ds_read_b128 v[20:23], v3 offset:33792
v_mfma_f32_16x16x32_bf16 v[36:39], v[196:199], v[8:11], v[36:39]
s_waitcnt lgkmcnt(2)
v_mfma_f32_16x16x32_bf16 v[32:35], v[200:203], v[12:15], v[32:35]
ds_read_b128 v[8:11], v2 offset:35840
v_mfma_f32_16x16x32_bf16 v[36:39], v[204:207], v[12:15], v[36:39]
s_waitcnt lgkmcnt(2)
v_mfma_f32_16x16x32_bf16 v[32:35], v[208:211], v[16:19], v[32:35]
ds_read_b128 v[12:15], v3 offset:35840
v_mfma_f32_16x16x32_bf16 v[36:39], v[212:215], v[16:19], v[36:39]
s_waitcnt lgkmcnt(2)
v_mfma_f32_16x16x32_bf16 v[32:35], v[216:219], v[20:23], v[32:35]
ds_read_b128 v[16:19], v2 offset:37888
v_mfma_f32_16x16x32_bf16 v[36:39], v[220:223], v[20:23], v[36:39]
s_waitcnt lgkmcnt(2)
v_mfma_f32_16x16x32_bf16 v[32:35], v[224:227], v[8:11], v[32:35]
ds_read_b128 v[20:23], v3 offset:37888
v_mfma_f32_16x16x32_bf16 v[36:39], v[228:231], v[8:11], v[36:39]
s_waitcnt lgkmcnt(2)
v_mfma_f32_16x16x32_bf16 v[32:35], v[232:235], v[12:15], v[32:35]
s_barrier
ds_read_b128 v[8:11], v2 offset:39936
v_mfma_f32_16x16x32_bf16 v[36:39], v[236:239], v[12:15], v[36:39]
s_waitcnt lgkmcnt(2)
v_mfma_f32_16x16x32_bf16 v[32:35], v[240:243], v[16:19], v[32:35]
ds_read_b128 v[12:15], v3 offset:39936
v_mfma_f32_16x16x32_bf16 v[36:39], v[244:247], v[16:19], v[36:39]
s_waitcnt lgkmcnt(2)
v_mfma_f32_16x16x32_bf16 v[32:35], v[248:251], v[20:23], v[32:35]
ds_read_b128 v[16:19], v2 offset:41984
v_mfma_f32_16x16x32_bf16 v[36:39], v[252:255], v[20:23], v[36:39]
s_waitcnt lgkmcnt(2)
v_mfma_f32_16x16x32_bf16 v[24:27], v[112:115], v[8:11], 0
ds_read_b128 v[20:23], v3 offset:41984
v_mfma_f32_16x16x32_bf16 v[28:31], v[116:119], v[8:11], 0
s_waitcnt lgkmcnt(2)
v_mfma_f32_16x16x32_bf16 v[24:27], v[120:123], v[12:15], v[24:27]
ds_read_b128 v[8:11], v2 offset:44032
v_mfma_f32_16x16x32_bf16 v[28:31], v[124:127], v[12:15], v[28:31]
s_waitcnt lgkmcnt(2)
v_mfma_f32_16x16x32_bf16 v[24:27], v[128:131], v[16:19], v[24:27]
ds_read_b128 v[12:15], v3 offset:44032
v_cvt_pk_bf16_f32 v32, v32, v36
v_mfma_f32_16x16x32_bf16 v[28:31], v[132:135], v[16:19], v[28:31]
s_waitcnt lgkmcnt(2)
v_cvt_pk_bf16_f32 v33, v33, v37
v_mfma_f32_16x16x32_bf16 v[24:27], v[136:139], v[20:23], v[24:27]
ds_read_b128 v[16:19], v2 offset:46080
v_cvt_pk_bf16_f32 v34, v34, v38
v_mfma_f32_16x16x32_bf16 v[28:31], v[140:143], v[20:23], v[28:31]
s_waitcnt lgkmcnt(2)
ds_write_b64 v5, v[32:33] offset:16384
v_mfma_f32_16x16x32_bf16 v[24:27], v[144:147], v[8:11], v[24:27]
ds_read_b128 v[20:23], v3 offset:46080
v_cvt_pk_bf16_f32 v35, v35, v39
v_mfma_f32_16x16x32_bf16 v[28:31], v[148:151], v[8:11], v[28:31]
s_waitcnt lgkmcnt(3)
ds_write_b64 v5, v[34:35] offset:18432
v_mfma_f32_16x16x32_bf16 v[24:27], v[152:155], v[12:15], v[24:27]
ds_read_b128 v[8:11], v2 offset:48128
v_mfma_f32_16x16x32_bf16 v[28:31], v[156:159], v[12:15], v[28:31]
s_waitcnt lgkmcnt(4)
v_mfma_f32_16x16x32_bf16 v[24:27], v[160:163], v[16:19], v[24:27]
ds_read_b128 v[12:15], v3 offset:48128
v_mfma_f32_16x16x32_bf16 v[28:31], v[164:167], v[16:19], v[28:31]
s_waitcnt lgkmcnt(3)
v_mfma_f32_16x16x32_bf16 v[24:27], v[168:171], v[20:23], v[24:27]
ds_read_b128 v[16:19], v2 offset:50176
v_mfma_f32_16x16x32_bf16 v[28:31], v[172:175], v[20:23], v[28:31]
s_waitcnt lgkmcnt(2)
v_mfma_f32_16x16x32_bf16 v[24:27], v[176:179], v[8:11], v[24:27]
ds_read_b128 v[20:23], v3 offset:50176
v_mfma_f32_16x16x32_bf16 v[28:31], v[180:183], v[8:11], v[28:31]
s_waitcnt lgkmcnt(2)
v_mfma_f32_16x16x32_bf16 v[24:27], v[184:187], v[12:15], v[24:27]
ds_read_b128 v[8:11], v2 offset:52224
v_mfma_f32_16x16x32_bf16 v[28:31], v[188:191], v[12:15], v[28:31]
s_waitcnt lgkmcnt(2)
v_mfma_f32_16x16x32_bf16 v[24:27], v[192:195], v[16:19], v[24:27]
ds_read_b128 v[12:15], v3 offset:52224
v_mfma_f32_16x16x32_bf16 v[28:31], v[196:199], v[16:19], v[28:31]
s_waitcnt lgkmcnt(2)
v_mfma_f32_16x16x32_bf16 v[24:27], v[200:203], v[20:23], v[24:27]
ds_read_b128 v[16:19], v2 offset:54272
v_mfma_f32_16x16x32_bf16 v[28:31], v[204:207], v[20:23], v[28:31]
s_waitcnt lgkmcnt(2)
v_mfma_f32_16x16x32_bf16 v[24:27], v[208:211], v[8:11], v[24:27]
ds_read_b128 v[20:23], v3 offset:54272
v_mfma_f32_16x16x32_bf16 v[28:31], v[212:215], v[8:11], v[28:31]
s_waitcnt lgkmcnt(2)
v_mfma_f32_16x16x32_bf16 v[24:27], v[216:219], v[12:15], v[24:27]
ds_read_b128 v[8:11], v2 offset:56320
v_mfma_f32_16x16x32_bf16 v[28:31], v[220:223], v[12:15], v[28:31]
s_waitcnt lgkmcnt(2)
v_mfma_f32_16x16x32_bf16 v[24:27], v[224:227], v[16:19], v[24:27]
ds_read_b128 v[12:15], v3 offset:56320
v_mfma_f32_16x16x32_bf16 v[28:31], v[228:231], v[16:19], v[28:31]
s_waitcnt lgkmcnt(2)
v_mfma_f32_16x16x32_bf16 v[24:27], v[232:235], v[20:23], v[24:27]
s_barrier
ds_read_b128 v[16:19], v2 offset:58368
v_mfma_f32_16x16x32_bf16 v[28:31], v[236:239], v[20:23], v[28:31]
s_waitcnt lgkmcnt(2)
v_mfma_f32_16x16x32_bf16 v[24:27], v[240:243], v[8:11], v[24:27]
ds_read_b128 v[20:23], v3 offset:58368
v_mfma_f32_16x16x32_bf16 v[28:31], v[244:247], v[8:11], v[28:31]
s_waitcnt lgkmcnt(2)
v_mfma_f32_16x16x32_bf16 v[24:27], v[248:251], v[12:15], v[24:27]
ds_read_b128 v[8:11], v0 offset:0
v_mfma_f32_16x16x32_bf16 v[28:31], v[252:255], v[12:15], v[28:31]
s_waitcnt lgkmcnt(2)
v_mfma_f32_16x16x32_bf16 v[32:35], v[112:115], v[16:19], 0
ds_read_b128 v[12:15], v1 offset:0
v_mfma_f32_16x16x32_bf16 v[36:39], v[116:119], v[16:19], 0
s_waitcnt lgkmcnt(2)
v_mfma_f32_16x16x32_bf16 v[32:35], v[120:123], v[20:23], v[32:35]
ds_read_b128 v[16:19], v0 offset:2048
v_mfma_f32_16x16x32_bf16 v[36:39], v[124:127], v[20:23], v[36:39]
s_waitcnt lgkmcnt(2)
L_pad3:
s_cmp_eq_u32 s57, 1
s_cbranch_scc1 L_wret
v_mfma_f32_16x16x32_bf16 v[32:35], v[128:131], v[8:11], v[32:35]
ds_read_b128 v[20:23], v1 offset:2048
v_cvt_pk_bf16_f32 v24, v24, v28
v_mfma_f32_16x16x32_bf16 v[36:39], v[132:135], v[8:11], v[36:39]
s_waitcnt lgkmcnt(2)
v_cvt_pk_bf16_f32 v25, v25, v29
v_mfma_f32_16x16x32_bf16 v[32:35], v[136:139], v[12:15], v[32:35]
ds_read_b128 v[8:11], v0 offset:4096
v_cvt_pk_bf16_f32 v26, v26, v30
v_mfma_f32_16x16x32_bf16 v[36:39], v[140:143], v[12:15], v[36:39]
s_waitcnt lgkmcnt(2)
ds_write_b64 v5, v[24:25] offset:20480
v_mfma_f32_16x16x32_bf16 v[32:35], v[144:147], v[16:19], v[32:35]
ds_read_b128 v[12:15], v1 offset:4096
v_cvt_pk_bf16_f32 v27, v27, v31
v_mfma_f32_16x16x32_bf16 v[36:39], v[148:151], v[16:19], v[36:39]
s_waitcnt lgkmcnt(3)
ds_write_b64 v5, v[26:27] offset:22528
v_mfma_f32_16x16x32_bf16 v[32:35], v[152:155], v[20:23], v[32:35]
ds_read_b128 v[16:19], v0 offset:6144
v_cvt_pk_bf16_f32 v48, v48, v52
v_mfma_f32_16x16x32_bf16 v[36:39], v[156:159], v[20:23], v[36:39]
s_waitcnt lgkmcnt(4)
v_cvt_pk_bf16_f32 v49, v49, v53
v_mfma_f32_16x16x32_bf16 v[32:35], v[160:163], v[8:11], v[32:35]
ds_read_b128 v[20:23], v1 offset:6144
v_cvt_pk_bf16_f32 v50, v50, v54
v_mfma_f32_16x16x32_bf16 v[36:39], v[164:167], v[8:11], v[36:39]
s_waitcnt lgkmcnt(3)
ds_write_b64 v5, v[48:49] offset:24576
v_mfma_f32_16x16x32_bf16 v[32:35], v[168:171], v[12:15], v[32:35]
ds_read_b128 v[8:11], v0 offset:8192
v_cvt_pk_bf16_f32 v51, v51, v55
v_mfma_f32_16x16x32_bf16 v[36:39], v[172:175], v[12:15], v[36:39]
s_waitcnt lgkmcnt(3)
ds_write_b64 v5, v[50:51] offset:26624
v_mfma_f32_16x16x32_bf16 v[32:35], v[176:179], v[16:19], v[32:35]
ds_read_b128 v[12:15], v1 offset:8192
v_mfma_f32_16x16x32_bf16 v[36:39], v[180:183], v[16:19], v[36:39]
s_waitcnt lgkmcnt(4)
v_mfma_f32_16x16x32_bf16 v[32:35], v[184:187], v[20:23], v[32:35]
ds_read_b128 v[16:19], v0 offset:10240
v_mfma_f32_16x16x32_bf16 v[36:39], v[188:191], v[20:23], v[36:39]
s_waitcnt lgkmcnt(3)
v_mfma_f32_16x16x32_bf16 v[32:35], v[192:195], v[8:11], v[32:35]
ds_read_b128 v[20:23], v1 offset:10240
v_mfma_f32_16x16x32_bf16 v[36:39], v[196:199], v[8:11], v[36:39]
s_waitcnt lgkmcnt(2)
v_mfma_f32_16x16x32_bf16 v[32:35], v[200:203], v[12:15], v[32:35]
ds_read_b128 v[8:11], v0 offset:12288
v_mfma_f32_16x16x32_bf16 v[36:39], v[204:207], v[12:15], v[36:39]
s_waitcnt lgkmcnt(2)
v_mfma_f32_16x16x32_bf16 v[32:35], v[208:211], v[16:19], v[32:35]
ds_read_b128 v[12:15], v1 offset:12288
v_mfma_f32_16x16x32_bf16 v[36:39], v[212:215], v[16:19], v[36:39]
s_waitcnt lgkmcnt(2)
v_mfma_f32_16x16x32_bf16 v[32:35], v[216:219], v[20:23], v[32:35]
ds_read_b128 v[16:19], v0 offset:14336
v_mfma_f32_16x16x32_bf16 v[36:39], v[220:223], v[20:23], v[36:39]
s_waitcnt lgkmcnt(2)
v_mfma_f32_16x16x32_bf16 v[32:35], v[224:227], v[8:11], v[32:35]
ds_read_b128 v[20:23], v1 offset:14336
v_mfma_f32_16x16x32_bf16 v[36:39], v[228:231], v[8:11], v[36:39]
s_waitcnt lgkmcnt(2)
v_mfma_f32_16x16x32_bf16 v[32:35], v[232:235], v[12:15], v[32:35]
s_barrier
ds_read_b128 v[8:11], v0 offset:16384
v_mfma_f32_16x16x32_bf16 v[36:39], v[236:239], v[12:15], v[36:39]
s_waitcnt lgkmcnt(2)
v_mfma_f32_16x16x32_bf16 v[32:35], v[240:243], v[16:19], v[32:35]
ds_read_b128 v[12:15], v1 offset:16384
v_mfma_f32_16x16x32_bf16 v[36:39], v[244:247], v[16:19], v[36:39]
s_waitcnt lgkmcnt(2)
v_mfma_f32_16x16x32_bf16 v[32:35], v[248:251], v[20:23], v[32:35]
ds_read_b128 v[16:19], v0 offset:18432
v_mfma_f32_16x16x32_bf16 v[36:39], v[252:255], v[20:23], v[36:39]
s_waitcnt lgkmcnt(2)
v_mfma_f32_16x16x32_bf16 v[24:27], v[112:115], v[8:11], 0
ds_read_b128 v[20:23], v1 offset:18432
v_mfma_f32_16x16x32_bf16 v[28:31], v[116:119], v[8:11], 0
s_waitcnt lgkmcnt(2)
v_mfma_f32_16x16x32_bf16 v[24:27], v[120:123], v[12:15], v[24:27]
ds_read_b128 v[8:11], v0 offset:20480
v_mfma_f32_16x16x32_bf16 v[28:31], v[124:127], v[12:15], v[28:31]
s_waitcnt lgkmcnt(2)
v_mfma_f32_16x16x32_bf16 v[24:27], v[128:131], v[16:19], v[24:27]
ds_read_b128 v[12:15], v1 offset:20480
v_cvt_pk_bf16_f32 v32, v32, v36
v_mfma_f32_16x16x32_bf16 v[28:31], v[132:135], v[16:19], v[28:31]
s_waitcnt lgkmcnt(2)
v_cvt_pk_bf16_f32 v33, v33, v37
v_mfma_f32_16x16x32_bf16 v[24:27], v[136:139], v[20:23], v[24:27]
ds_read_b128 v[16:19], v0 offset:22528
v_cvt_pk_bf16_f32 v34, v34, v38
v_mfma_f32_16x16x32_bf16 v[28:31], v[140:143], v[20:23], v[28:31]
s_waitcnt lgkmcnt(2)
ds_write_b64 v5, v[32:33] offset:28672
v_mfma_f32_16x16x32_bf16 v[24:27], v[144:147], v[8:11], v[24:27]
ds_read_b128 v[20:23], v1 offset:22528
v_cvt_pk_bf16_f32 v35, v35, v39
v_mfma_f32_16x16x32_bf16 v[28:31], v[148:151], v[8:11], v[28:31]
s_waitcnt lgkmcnt(3)
ds_write_b64 v5, v[34:35] offset:30720
v_mfma_f32_16x16x32_bf16 v[24:27], v[152:155], v[12:15], v[24:27]
ds_read_b128 v[8:11], v0 offset:24576
v_cvt_pk_bf16_f32 v56, v56, v60
v_mfma_f32_16x16x32_bf16 v[28:31], v[156:159], v[12:15], v[28:31]
s_waitcnt lgkmcnt(4)
v_cvt_pk_bf16_f32 v57, v57, v61
v_mfma_f32_16x16x32_bf16 v[24:27], v[160:163], v[16:19], v[24:27]
ds_read_b128 v[12:15], v1 offset:24576
v_cvt_pk_bf16_f32 v58, v58, v62
v_mfma_f32_16x16x32_bf16 v[28:31], v[164:167], v[16:19], v[28:31]
s_waitcnt lgkmcnt(3)
ds_write_b64 v5, v[56:57] offset:32768
v_mfma_f32_16x16x32_bf16 v[24:27], v[168:171], v[20:23], v[24:27]
ds_read_b128 v[16:19], v0 offset:26624
v_cvt_pk_bf16_f32 v59, v59, v63
v_mfma_f32_16x16x32_bf16 v[28:31], v[172:175], v[20:23], v[28:31]
s_waitcnt lgkmcnt(3)
ds_write_b64 v5, v[58:59] offset:34816
v_mfma_f32_16x16x32_bf16 v[24:27], v[176:179], v[8:11], v[24:27]
ds_read_b128 v[20:23], v1 offset:26624
v_cvt_pk_bf16_f32 v64, v64, v68
v_mfma_f32_16x16x32_bf16 v[28:31], v[180:183], v[8:11], v[28:31]
s_waitcnt lgkmcnt(4)
v_cvt_pk_bf16_f32 v65, v65, v69
v_mfma_f32_16x16x32_bf16 v[24:27], v[184:187], v[12:15], v[24:27]
ds_read_b128 v[8:11], v0 offset:28672
v_cvt_pk_bf16_f32 v66, v66, v70
v_mfma_f32_16x16x32_bf16 v[28:31], v[188:191], v[12:15], v[28:31]
s_waitcnt lgkmcnt(3)
ds_write_b64 v5, v[64:65] offset:36864
v_mfma_f32_16x16x32_bf16 v[24:27], v[192:195], v[16:19], v[24:27]
ds_read_b128 v[12:15], v1 offset:28672
v_cvt_pk_bf16_f32 v67, v67, v71
v_mfma_f32_16x16x32_bf16 v[28:31], v[196:199], v[16:19], v[28:31]
s_waitcnt lgkmcnt(3)
ds_write_b64 v5, v[66:67] offset:38912
v_mfma_f32_16x16x32_bf16 v[24:27], v[200:203], v[20:23], v[24:27]
ds_read_b128 v[16:19], v0 offset:30720
v_mfma_f32_16x16x32_bf16 v[28:31], v[204:207], v[20:23], v[28:31]
s_waitcnt lgkmcnt(4)
v_mfma_f32_16x16x32_bf16 v[24:27], v[208:211], v[8:11], v[24:27]
ds_read_b128 v[20:23], v1 offset:30720
v_mfma_f32_16x16x32_bf16 v[28:31], v[212:215], v[8:11], v[28:31]
s_waitcnt lgkmcnt(3)
v_mfma_f32_16x16x32_bf16 v[24:27], v[216:219], v[12:15], v[24:27]
ds_read_b128 v[8:11], v0 offset:32768
v_mfma_f32_16x16x32_bf16 v[28:31], v[220:223], v[12:15], v[28:31]
s_waitcnt lgkmcnt(2)
v_mfma_f32_16x16x32_bf16 v[24:27], v[224:227], v[16:19], v[24:27]
ds_read_b128 v[12:15], v1 offset:32768
v_mfma_f32_16x16x32_bf16 v[28:31], v[228:231], v[16:19], v[28:31]
s_waitcnt lgkmcnt(2)
v_mfma_f32_16x16x32_bf16 v[24:27], v[232:235], v[20:23], v[24:27]
s_barrier
ds_read_b128 v[16:19], v0 offset:34816
v_mfma_f32_16x16x32_bf16 v[28:31], v[236:239], v[20:23], v[28:31]
s_waitcnt lgkmcnt(2)
v_mfma_f32_16x16x32_bf16 v[24:27], v[240:243], v[8:11], v[24:27]
ds_read_b128 v[20:23], v1 offset:34816
v_mfma_f32_16x16x32_bf16 v[28:31], v[244:247], v[8:11], v[28:31]
s_waitcnt lgkmcnt(2)
v_mfma_f32_16x16x32_bf16 v[24:27], v[248:251], v[12:15], v[24:27]
ds_read_b128 v[8:11], v0 offset:36864
v_mfma_f32_16x16x32_bf16 v[28:31], v[252:255], v[12:15], v[28:31]
s_waitcnt lgkmcnt(2)
v_mfma_f32_16x16x32_bf16 v[32:35], v[112:115], v[16:19], 0
ds_read_b128 v[12:15], v1 offset:36864
v_mfma_f32_16x16x32_bf16 v[36:39], v[116:119], v[16:19], 0
s_waitcnt lgkmcnt(2)
v_mfma_f32_16x16x32_bf16 v[32:35], v[120:123], v[20:23], v[32:35]
ds_read_b128 v[16:19], v0 offset:38912
v_mfma_f32_16x16x32_bf16 v[36:39], v[124:127], v[20:23], v[36:39]
s_waitcnt lgkmcnt(2)
v_mfma_f32_16x16x32_bf16 v[32:35], v[128:131], v[8:11], v[32:35]
ds_read_b128 v[20:23], v1 offset:38912
v_cvt_pk_bf16_f32 v24, v24, v28
v_mfma_f32_16x16x32_bf16 v[36:39], v[132:135], v[8:11], v[36:39]
s_waitcnt lgkmcnt(2)
v_cvt_pk_bf16_f32 v25, v25, v29
v_mfma_f32_16x16x32_bf16 v[32:35], v[136:139], v[12:15], v[32:35]
ds_read_b128 v[8:11], v0 offset:40960
v_cvt_pk_bf16_f32 v26, v26, v30
v_mfma_f32_16x16x32_bf16 v[36:39], v[140:143], v[12:15], v[36:39]
s_waitcnt lgkmcnt(2)
ds_write_b64 v5, v[24:25] offset:40960
v_mfma_f32_16x16x32_bf16 v[32:35], v[144:147], v[16:19], v[32:35]
ds_read_b128 v[12:15], v1 offset:40960
v_cvt_pk_bf16_f32 v27, v27, v31
v_mfma_f32_16x16x32_bf16 v[36:39], v[148:151], v[16:19], v[36:39]
s_waitcnt lgkmcnt(3)
ds_write_b64 v5, v[26:27] offset:43008
v_mfma_f32_16x16x32_bf16 v[32:35], v[152:155], v[20:23], v[32:35]
ds_read_b128 v[16:19], v0 offset:43008
v_cvt_pk_bf16_f32 v72, v72, v76
v_mfma_f32_16x16x32_bf16 v[36:39], v[156:159], v[20:23], v[36:39]
s_waitcnt lgkmcnt(4)
v_cvt_pk_bf16_f32 v73, v73, v77
v_mfma_f32_16x16x32_bf16 v[32:35], v[160:163], v[8:11], v[32:35]
ds_read_b128 v[20:23], v1 offset:43008
v_cvt_pk_bf16_f32 v74, v74, v78
v_mfma_f32_16x16x32_bf16 v[36:39], v[164:167], v[8:11], v[36:39]
s_waitcnt lgkmcnt(3)
ds_write_b64 v5, v[72:73] offset:0
v_mfma_f32_16x16x32_bf16 v[32:35], v[168:171], v[12:15], v[32:35]
ds_read_b128 v[8:11], v0 offset:45056
v_cvt_pk_bf16_f32 v75, v75, v79
v_mfma_f32_16x16x32_bf16 v[36:39], v[172:175], v[12:15], v[36:39]
s_waitcnt lgkmcnt(3)
ds_write_b64 v5, v[74:75] offset:2048
v_mfma_f32_16x16x32_bf16 v[32:35], v[176:179], v[16:19], v[32:35]
ds_read_b128 v[12:15], v1 offset:45056
v_cvt_pk_bf16_f32 v80, v80, v84
v_mfma_f32_16x16x32_bf16 v[36:39], v[180:183], v[16:19], v[36:39]
s_waitcnt lgkmcnt(4)
v_cvt_pk_bf16_f32 v81, v81, v85
v_mfma_f32_16x16x32_bf16 v[32:35], v[184:187], v[20:23], v[32:35]
ds_read_b128 v[16:19], v0 offset:47104
v_cvt_pk_bf16_f32 v82, v82, v86
v_mfma_f32_16x16x32_bf16 v[36:39], v[188:191], v[20:23], v[36:39]
s_waitcnt lgkmcnt(3)
ds_write_b64 v5, v[80:81] offset:4096
v_mfma_f32_16x16x32_bf16 v[32:35], v[192:195], v[8:11], v[32:35]
ds_read_b128 v[20:23], v1 offset:47104
v_cvt_pk_bf16_f32 v83, v83, v87
v_mfma_f32_16x16x32_bf16 v[36:39], v[196:199], v[8:11], v[36:39]
s_waitcnt lgkmcnt(3)
ds_write_b64 v5, v[82:83] offset:6144
v_mfma_f32_16x16x32_bf16 v[32:35], v[200:203], v[12:15], v[32:35]
ds_read_b128 v[8:11], v0 offset:49152
v_mfma_f32_16x16x32_bf16 v[36:39], v[204:207], v[12:15], v[36:39]
s_waitcnt lgkmcnt(4)
v_mfma_f32_16x16x32_bf16 v[32:35], v[208:211], v[16:19], v[32:35]
ds_read_b128 v[12:15], v1 offset:49152
v_mfma_f32_16x16x32_bf16 v[36:39], v[212:215], v[16:19], v[36:39]
s_waitcnt lgkmcnt(3)
v_mfma_f32_16x16x32_bf16 v[32:35], v[216:219], v[20:23], v[32:35]
ds_read_b128 v[16:19], v0 offset:51200
v_mfma_f32_16x16x32_bf16 v[36:39], v[220:223], v[20:23], v[36:39]
s_waitcnt lgkmcnt(2)
v_mfma_f32_16x16x32_bf16 v[32:35], v[224:227], v[8:11], v[32:35]
ds_read_b128 v[20:23], v1 offset:51200
v_mfma_f32_16x16x32_bf16 v[36:39], v[228:231], v[8:11], v[36:39]
s_waitcnt lgkmcnt(2)
v_mfma_f32_16x16x32_bf16 v[32:35], v[232:235], v[12:15], v[32:35]
s_barrier
ds_read_b128 v[8:11], v0 offset:53248
v_mfma_f32_16x16x32_bf16 v[36:39], v[236:239], v[12:15], v[36:39]
s_waitcnt lgkmcnt(2)
v_mfma_f32_16x16x32_bf16 v[32:35], v[240:243], v[16:19], v[32:35]
ds_read_b128 v[12:15], v1 offset:53248
v_mfma_f32_16x16x32_bf16 v[36:39], v[244:247], v[16:19], v[36:39]
s_waitcnt lgkmcnt(2)
v_mfma_f32_16x16x32_bf16 v[32:35], v[248:251], v[20:23], v[32:35]
ds_read_b128 v[16:19], v0 offset:55296
v_mfma_f32_16x16x32_bf16 v[36:39], v[252:255], v[20:23], v[36:39]
s_waitcnt lgkmcnt(2)
v_mfma_f32_16x16x32_bf16 v[24:27], v[112:115], v[8:11], 0
ds_read_b128 v[20:23], v1 offset:55296
v_mfma_f32_16x16x32_bf16 v[28:31], v[116:119], v[8:11], 0
s_waitcnt lgkmcnt(2)
v_mfma_f32_16x16x32_bf16 v[24:27], v[120:123], v[12:15], v[24:27]
ds_read_b128 v[8:11], v0 offset:57344
v_mfma_f32_16x16x32_bf16 v[28:31], v[124:127], v[12:15], v[28:31]
s_waitcnt lgkmcnt(2)
v_mfma_f32_16x16x32_bf16 v[24:27], v[128:131], v[16:19], v[24:27]
ds_read_b128 v[12:15], v1 offset:57344
v_cvt_pk_bf16_f32 v32, v32, v36
v_mfma_f32_16x16x32_bf16 v[28:31], v[132:135], v[16:19], v[28:31]
s_waitcnt lgkmcnt(2)
v_cvt_pk_bf16_f32 v33, v33, v37
v_mfma_f32_16x16x32_bf16 v[24:27], v[136:139], v[20:23], v[24:27]
ds_read_b128 v[16:19], v0 offset:59392
v_cvt_pk_bf16_f32 v34, v34, v38
v_mfma_f32_16x16x32_bf16 v[28:31], v[140:143], v[20:23], v[28:31]
s_waitcnt lgkmcnt(2)
ds_write_b64 v5, v[32:33] offset:8192
v_mfma_f32_16x16x32_bf16 v[24:27], v[144:147], v[8:11], v[24:27]
ds_read_b128 v[20:23], v1 offset:59392
v_cvt_pk_bf16_f32 v35, v35, v39
v_mfma_f32_16x16x32_bf16 v[28:31], v[148:151], v[8:11], v[28:31]
s_waitcnt lgkmcnt(3)
ds_write_b64 v5, v[34:35] offset:10240
v_mfma_f32_16x16x32_bf16 v[24:27], v[152:155], v[12:15], v[24:27]
ds_read_b128 v[8:11], v0 offset:61440
v_cvt_pk_bf16_f32 v88, v88, v92
v_mfma_f32_16x16x32_bf16 v[28:31], v[156:159], v[12:15], v[28:31]
s_waitcnt lgkmcnt(4)
v_cvt_pk_bf16_f32 v89, v89, v93
v_mfma_f32_16x16x32_bf16 v[24:27], v[160:163], v[16:19], v[24:27]
ds_read_b128 v[12:15], v1 offset:61440
v_cvt_pk_bf16_f32 v90, v90, v94
v_mfma_f32_16x16x32_bf16 v[28:31], v[164:167], v[16:19], v[28:31]
s_waitcnt lgkmcnt(3)
ds_write_b64 v5, v[88:89] offset:12288
v_mfma_f32_16x16x32_bf16 v[24:27], v[168:171], v[20:23], v[24:27]
ds_read_b128 v[16:19], v0 offset:63488
v_cvt_pk_bf16_f32 v91, v91, v95
v_mfma_f32_16x16x32_bf16 v[28:31], v[172:175], v[20:23], v[28:31]
s_waitcnt lgkmcnt(3)
ds_write_b64 v5, v[90:91] offset:14336
v_mfma_f32_16x16x32_bf16 v[24:27], v[176:179], v[8:11], v[24:27]
ds_read_b128 v[20:23], v1 offset:63488
v_cvt_pk_bf16_f32 v96, v96, v100
v_mfma_f32_16x16x32_bf16 v[28:31], v[180:183], v[8:11], v[28:31]
s_waitcnt lgkmcnt(4)
v_cvt_pk_bf16_f32 v97, v97, v101
v_mfma_f32_16x16x32_bf16 v[24:27], v[184:187], v[12:15], v[24:27]
ds_read_b128 v[8:11], v2 offset:7168
v_cvt_pk_bf16_f32 v98, v98, v102
v_mfma_f32_16x16x32_bf16 v[28:31], v[188:191], v[12:15], v[28:31]
s_waitcnt lgkmcnt(3)
ds_write_b64 v5, v[96:97] offset:16384
v_mfma_f32_16x16x32_bf16 v[24:27], v[192:195], v[16:19], v[24:27]
ds_read_b128 v[12:15], v3 offset:7168
v_cvt_pk_bf16_f32 v99, v99, v103
v_mfma_f32_16x16x32_bf16 v[28:31], v[196:199], v[16:19], v[28:31]
s_waitcnt lgkmcnt(3)
ds_write_b64 v5, v[98:99] offset:18432
v_mfma_f32_16x16x32_bf16 v[24:27], v[200:203], v[20:23], v[24:27]
ds_read_b128 v[16:19], v2 offset:9216
v_mfma_f32_16x16x32_bf16 v[28:31], v[204:207], v[20:23], v[28:31]
s_waitcnt lgkmcnt(4)
v_mfma_f32_16x16x32_bf16 v[24:27], v[208:211], v[8:11], v[24:27]
ds_read_b128 v[20:23], v3 offset:9216
v_mfma_f32_16x16x32_bf16 v[28:31], v[212:215], v[8:11], v[28:31]
s_waitcnt lgkmcnt(3)
v_mfma_f32_16x16x32_bf16 v[24:27], v[216:219], v[12:15], v[24:27]
ds_read_b128 v[8:11], v2 offset:11264
v_mfma_f32_16x16x32_bf16 v[28:31], v[220:223], v[12:15], v[28:31]
s_waitcnt lgkmcnt(2)
v_mfma_f32_16x16x32_bf16 v[24:27], v[224:227], v[16:19], v[24:27]
ds_read_b128 v[12:15], v3 offset:11264
v_mfma_f32_16x16x32_bf16 v[28:31], v[228:231], v[16:19], v[28:31]
s_waitcnt lgkmcnt(2)
v_mfma_f32_16x16x32_bf16 v[24:27], v[232:235], v[20:23], v[24:27]
s_barrier
ds_read_b128 v[16:19], v2 offset:13312
v_mfma_f32_16x16x32_bf16 v[28:31], v[236:239], v[20:23], v[28:31]
s_waitcnt lgkmcnt(2)
v_mfma_f32_16x16x32_bf16 v[24:27], v[240:243], v[8:11], v[24:27]
ds_read_b128 v[20:23], v3 offset:13312
v_mfma_f32_16x16x32_bf16 v[28:31], v[244:247], v[8:11], v[28:31]
s_waitcnt lgkmcnt(2)
v_mfma_f32_16x16x32_bf16 v[24:27], v[248:251], v[12:15], v[24:27]
ds_read_b128 v[8:11], v2 offset:15360
v_mfma_f32_16x16x32_bf16 v[28:31], v[252:255], v[12:15], v[28:31]
s_waitcnt lgkmcnt(2)
v_mfma_f32_16x16x32_bf16 v[32:35], v[112:115], v[16:19], 0
ds_read_b128 v[12:15], v3 offset:15360
v_mfma_f32_16x16x32_bf16 v[36:39], v[116:119], v[16:19], 0
s_waitcnt lgkmcnt(2)
v_mfma_f32_16x16x32_bf16 v[32:35], v[120:123], v[20:23], v[32:35]
ds_read_b128 v[16:19], v2 offset:17408
v_mfma_f32_16x16x32_bf16 v[36:39], v[124:127], v[20:23], v[36:39]
s_waitcnt lgkmcnt(2)
v_mfma_f32_16x16x32_bf16 v[32:35], v[128:131], v[8:11], v[32:35]
ds_read_b128 v[20:23], v3 offset:17408
v_cvt_pk_bf16_f32 v24, v24, v28
v_mfma_f32_16x16x32_bf16 v[36:39], v[132:135], v[8:11], v[36:39]
s_waitcnt lgkmcnt(2)
v_cvt_pk_bf16_f32 v25, v25, v29
v_mfma_f32_16x16x32_bf16 v[32:35], v[136:139], v[12:15], v[32:35]
ds_read_b128 v[8:11], v2 offset:19456
v_cvt_pk_bf16_f32 v26, v26, v30
v_mfma_f32_16x16x32_bf16 v[36:39], v[140:143], v[12:15], v[36:39]
s_waitcnt lgkmcnt(2)
ds_write_b64 v5, v[24:25] offset:20480
v_mfma_f32_16x16x32_bf16 v[32:35], v[144:147], v[16:19], v[32:35]
ds_read_b128 v[12:15], v3 offset:19456
v_cvt_pk_bf16_f32 v27, v27, v31
v_mfma_f32_16x16x32_bf16 v[36:39], v[148:151], v[16:19], v[36:39]
s_waitcnt lgkmcnt(3)
ds_write_b64 v5, v[26:27] offset:22528
v_mfma_f32_16x16x32_bf16 v[32:35], v[152:155], v[20:23], v[32:35]
ds_read_b128 v[16:19], v2 offset:21504
v_mfma_f32_16x16x32_bf16 v[36:39], v[156:159], v[20:23], v[36:39]
s_waitcnt lgkmcnt(4)
v_mfma_f32_16x16x32_bf16 v[32:35], v[160:163], v[8:11], v[32:35]
ds_read_b128 v[20:23], v3 offset:21504
v_mfma_f32_16x16x32_bf16 v[36:39], v[164:167], v[8:11], v[36:39]
s_waitcnt lgkmcnt(3)
v_mfma_f32_16x16x32_bf16 v[32:35], v[168:171], v[12:15], v[32:35]
ds_read_b128 v[8:11], v2 offset:23552
v_mfma_f32_16x16x32_bf16 v[36:39], v[172:175], v[12:15], v[36:39]
s_waitcnt lgkmcnt(2)
v_mfma_f32_16x16x32_bf16 v[32:35], v[176:179], v[16:19], v[32:35]
ds_read_b128 v[12:15], v3 offset:23552
v_mfma_f32_16x16x32_bf16 v[36:39], v[180:183], v[16:19], v[36:39]
s_waitcnt lgkmcnt(2)
v_mfma_f32_16x16x32_bf16 v[32:35], v[184:187], v[20:23], v[32:35]
ds_read_b128 v[16:19], v2 offset:25600
v_mfma_f32_16x16x32_bf16 v[36:39], v[188:191], v[20:23], v[36:39]
s_waitcnt lgkmcnt(2)
v_mfma_f32_16x16x32_bf16 v[32:35], v[192:195], v[8:11], v[32:35]
ds_read_b128 v[20:23], v3 offset:25600
v_mfma_f32_16x16x32_bf16 v[36:39], v[196:199], v[8:11], v[36:39]
s_waitcnt lgkmcnt(2)
s_cmp_lt_u32 s6, 2
s_cbranch_scc0 L_c18
v_mfma_f32_16x16x32_bf16 v[32:35], v[200:203], v[12:15], v[32:35]
ds_read_b128 v[8:11], v2 offset:27648
v_mfma_f32_16x16x32_bf16 v[36:39], v[204:207], v[12:15], v[36:39]
s_waitcnt lgkmcnt(2)
v_mfma_f32_16x16x32_bf16 v[32:35], v[208:211], v[16:19], v[32:35]
ds_read_b128 v[12:15], v3 offset:27648
v_mfma_f32_16x16x32_bf16 v[36:39], v[212:215], v[16:19], v[36:39]
s_waitcnt lgkmcnt(2)
v_mfma_f32_16x16x32_bf16 v[32:35], v[216:219], v[20:23], v[32:35]
ds_read_b128 v[16:19], v2 offset:29696
v_mfma_f32_16x16x32_bf16 v[36:39], v[220:223], v[20:23], v[36:39]
s_waitcnt lgkmcnt(2)
v_mfma_f32_16x16x32_bf16 v[32:35], v[224:227], v[8:11], v[32:35]
ds_read_b128 v[20:23], v3 offset:29696
v_mfma_f32_16x16x32_bf16 v[36:39], v[228:231], v[8:11], v[36:39]
s_waitcnt lgkmcnt(2)
v_mfma_f32_16x16x32_bf16 v[32:35], v[232:235], v[12:15], v[32:35]
s_barrier
ds_read_b128 v[8:11], v2 offset:31744
v_mfma_f32_16x16x32_bf16 v[36:39], v[236:239], v[12:15], v[36:39]
s_waitcnt lgkmcnt(2)
v_mfma_f32_16x16x32_bf16 v[32:35], v[240:243], v[16:19], v[32:35]
ds_read_b128 v[12:15], v3 offset:31744
v_mfma_f32_16x16x32_bf16 v[36:39], v[244:247], v[16:19], v[36:39]
s_waitcnt lgkmcnt(2)
v_mfma_f32_16x16x32_bf16 v[32:35], v[248:251], v[20:23], v[32:35]
ds_read_b128 v[16:19], v2 offset:33792
v_mfma_f32_16x16x32_bf16 v[36:39], v[252:255], v[20:23], v[36:39]
s_waitcnt lgkmcnt(2)
v_mfma_f32_16x16x32_bf16 v[24:27], v[112:115], v[8:11], 0
ds_read_b128 v[20:23], v3 offset:33792
v_mfma_f32_16x16x32_bf16 v[28:31], v[116:119], v[8:11], 0
s_waitcnt lgkmcnt(2)
v_mfma_f32_16x16x32_bf16 v[24:27], v[120:123], v[12:15], v[24:27]
ds_read_b128 v[8:11], v2 offset:35840
v_mfma_f32_16x16x32_bf16 v[28:31], v[124:127], v[12:15], v[28:31]
s_waitcnt lgkmcnt(2)
v_mfma_f32_16x16x32_bf16 v[24:27], v[128:131], v[16:19], v[24:27]
ds_read_b128 v[12:15], v3 offset:35840
v_cvt_pk_bf16_f32 v32, v32, v36
v_mfma_f32_16x16x32_bf16 v[28:31], v[132:135], v[16:19], v[28:31]
s_waitcnt lgkmcnt(2)
v_cvt_pk_bf16_f32 v33, v33, v37
v_mfma_f32_16x16x32_bf16 v[24:27], v[136:139], v[20:23], v[24:27]
ds_read_b128 v[16:19], v2 offset:37888
v_cvt_pk_bf16_f32 v34, v34, v38
v_mfma_f32_16x16x32_bf16 v[28:31], v[140:143], v[20:23], v[28:31]
s_waitcnt lgkmcnt(2)
ds_write_b64 v5, v[32:33] offset:24576
v_mfma_f32_16x16x32_bf16 v[24:27], v[144:147], v[8:11], v[24:27]
ds_read_b128 v[20:23], v3 offset:37888
v_cvt_pk_bf16_f32 v35, v35, v39
v_mfma_f32_16x16x32_bf16 v[28:31], v[148:151], v[8:11], v[28:31]
s_waitcnt lgkmcnt(3)
ds_write_b64 v5, v[34:35] offset:26624
v_mfma_f32_16x16x32_bf16 v[24:27], v[152:155], v[12:15], v[24:27]
ds_read_b128 v[8:11], v2 offset:39936
v_mfma_f32_16x16x32_bf16 v[28:31], v[156:159], v[12:15], v[28:31]
s_waitcnt lgkmcnt(4)
v_mfma_f32_16x16x32_bf16 v[24:27], v[160:163], v[16:19], v[24:27]
ds_read_b128 v[12:15], v3 offset:39936
v_mfma_f32_16x16x32_bf16 v[28:31], v[164:167], v[16:19], v[28:31]
s_waitcnt lgkmcnt(3)
v_mfma_f32_16x16x32_bf16 v[24:27], v[168:171], v[20:23], v[24:27]
ds_read_b128 v[16:19], v2 offset:41984
v_mfma_f32_16x16x32_bf16 v[28:31], v[172:175], v[20:23], v[28:31]
s_waitcnt lgkmcnt(2)
v_mfma_f32_16x16x32_bf16 v[24:27], v[176:179], v[8:11], v[24:27]
ds_read_b128 v[20:23], v3 offset:41984
v_mfma_f32_16x16x32_bf16 v[28:31], v[180:183], v[8:11], v[28:31]
s_waitcnt lgkmcnt(2)
v_mfma_f32_16x16x32_bf16 v[24:27], v[184:187], v[12:15], v[24:27]
ds_read_b128 v[8:11], v2 offset:44032
v_mfma_f32_16x16x32_bf16 v[28:31], v[188:191], v[12:15], v[28:31]
s_waitcnt lgkmcnt(2)
v_mfma_f32_16x16x32_bf16 v[24:27], v[192:195], v[16:19], v[24:27]
ds_read_b128 v[12:15], v3 offset:44032
v_mfma_f32_16x16x32_bf16 v[28:31], v[196:199], v[16:19], v[28:31]
s_waitcnt lgkmcnt(2)
s_waitcnt lgkmcnt(6)
s_barrier
v_mfma_f32_16x16x32_bf16 v[24:27], v[200:203], v[20:23], v[24:27]
ds_read_b128 v[16:19], v2 offset:46080
v_mfma_f32_16x16x32_bf16 v[28:31], v[204:207], v[20:23], v[28:31]
s_waitcnt lgkmcnt(2)
v_mfma_f32_16x16x32_bf16 v[24:27], v[208:211], v[8:11], v[24:27]
ds_read_b128 v[20:23], v3 offset:46080
v_mfma_f32_16x16x32_bf16 v[28:31], v[212:215], v[8:11], v[28:31]
s_waitcnt lgkmcnt(2)
v_mfma_f32_16x16x32_bf16 v[24:27], v[216:219], v[12:15], v[24:27]
ds_read_b128 v[8:11], v2 offset:48128
v_mfma_f32_16x16x32_bf16 v[28:31], v[220:223], v[12:15], v[28:31]
s_waitcnt lgkmcnt(2)
v_mfma_f32_16x16x32_bf16 v[24:27], v[224:227], v[16:19], v[24:27]
ds_read_b128 v[12:15], v3 offset:48128
v_mfma_f32_16x16x32_bf16 v[28:31], v[228:231], v[16:19], v[28:31]
s_waitcnt lgkmcnt(2)
v_mfma_f32_16x16x32_bf16 v[24:27], v[232:235], v[20:23], v[24:27]
v_mfma_f32_16x16x32_bf16 v[28:31], v[236:239], v[20:23], v[28:31]
s_waitcnt lgkmcnt(1)
v_mfma_f32_16x16x32_bf16 v[24:27], v[240:243], v[8:11], v[24:27]
v_mfma_f32_16x16x32_bf16 v[28:31], v[244:247], v[8:11], v[28:31]
s_waitcnt lgkmcnt(0)
v_mfma_f32_16x16x32_bf16 v[24:27], v[248:251], v[12:15], v[24:27]
v_mfma_f32_16x16x32_bf16 v[28:31], v[252:255], v[12:15], v[28:31]
s_nop 7
v_cvt_pk_bf16_f32 v24, v24, v28
v_cvt_pk_bf16_f32 v25, v25, v29
v_cvt_pk_bf16_f32 v26, v26, v30
ds_write_b64 v5, v[24:25] offset:28672
v_cvt_pk_bf16_f32 v27, v27, v31
ds_write_b64 v5, v[26:27] offset:30720
s_waitcnt lgkmcnt(0)
s_barrier
L_end:
s_endpgm
.section .rodata,"a"
.p2align 6
.amdhsa_kernel standalone__weight_only_int_omniquant__prompt_kernel
  .amdhsa_next_free_vgpr 256
  .amdhsa_next_free_sgpr 102
  .amdhsa_accum_offset 256
  .amdhsa_group_segment_fixed_size 0
  .amdhsa_kernarg_size 64
  .amdhsa_user_sgpr_count 2
  .amdhsa_user_sgpr_kernarg_segment_ptr 1
  .amdhsa_system_sgpr_workgroup_id_x 1
  .amdhsa_float_denorm_mode_32 3
.end_amdhsa_kernel
```
